```python
import torch

def _softmax(x, axis=-1):
    return torch.softmax(x, dim=axis)
def _gelu(x):
    return torch.nn.functional.gelu(x, approximate="tanh")
def _silu(x):
    return torch.nn.functional.silu(x)
def _sigmoid(x):
    return torch.sigmoid(x)
def _layernorm(x, axis=-1, eps=1e-5):
    m = x.mean(dim=axis, keepdim=True)
    v = x.var(dim=axis, keepdim=True, unbiased=False)
    return (x - m) / torch.sqrt(v + eps)
def _scatter_add(tgt, idx, src, axis=0):
    return tgt.clone().index_add_(axis, idx, src)
def _segment_sum(src, seg, n):
    out = torch.zeros((n,) + src.shape[1:], dtype=src.dtype)
    return out.index_add_(0, seg, src)
def _pad(x, pw):
    flat = tuple(v for pair in reversed(pw) for v in pair)
    return torch.nn.functional.pad(x, flat)

kernel_name = 'concat_heads__softmax_full_mha__mha_block__prompt'

def setup_inputs():

    _w = (lambda a: (lambda t: t.to(torch.bfloat16) if t.is_floating_point() else t)(torch.as_tensor(a)))
    def _A_setup():
        B, S, D = 1, 2048, 640
        return {
            "x": _w((lambda *s: torch.randn(*s, dtype=torch.bfloat16) * 0.2)(B, S, D)),
            "wqkv": _w((lambda *s: torch.randn(*s, dtype=torch.bfloat16) * 0.2)(D, 3 * D)),
            "wo": _w((lambda *s: torch.randn(*s, dtype=torch.bfloat16) * 0.05)(D, D)),
        }
    _A_in = _A_setup()

    def _B_setup():
        B, S, D, H = 1, 2048, 640, 32
        return {
            "x": _w((lambda *s: torch.randn(*s, dtype=torch.bfloat16) * 0.2)(B, S, D)),
            "wqkv": _w((lambda *s: torch.randn(*s, dtype=torch.bfloat16) * 0.2)(D, 3 * D)),
            "wo": _w((lambda *s: torch.randn(*s, dtype=torch.bfloat16) * 0.05)(D, D)),
        }
    _B_in = _B_setup()

    return {
        "A_x": _A_in["x"],
        "A_wqkv": _A_in["wqkv"],
        "A_wo": _A_in["wo"],
        "B_x": _B_in["x"],
        "B_wqkv": _B_in["wqkv"],
        "B_wo": _B_in["wo"],
    }

def reference(A_x, A_wqkv, A_wo, B_x, B_wqkv, B_wo):
    def _A_ref(x, wqkv, wo):
        B, S, D = x.shape
        H = 32; Dh = D // H
        qkv = (lambda x, *d: x.permute(*d))((x @ wqkv).reshape(B, S, 3, H, Dh), 2, 0, 3, 1, 4)
        q, k, v = qkv[0], qkv[1], qkv[2]
        scale = Dh ** -0.5
        scores = torch.einsum("bhqd,bhkd->bhqk", q, k) * scale
        p = _softmax(scores, axis=-1)
        o = torch.einsum("bhqk,bhkd->bhqd", p, v)
        return (lambda x, *d: x.permute(*d))(o, 0, 2, 1, 3).reshape(B, S, D) @ wo

    def _B_ref(x, wqkv, wo):
        B, S, D = x.shape
        H = 32
        Dh = D // H
        qkv = (lambda x, *d: x.permute(*d))((x @ wqkv).reshape(B, S, 3, H, Dh), 2, 0, 3, 1, 4)
        q, k, v = qkv[0], qkv[1], qkv[2]
        scores = torch.einsum("bhqd,bhkd->bhqk", q, k) * (Dh ** -0.5)
        p = _softmax(scores, axis=-1)
        o = torch.einsum("bhqk,bhkd->bhqd", p, v)
        return (lambda x, *d: x.permute(*d))(o, 0, 2, 1, 3).reshape(B, S, D) @ wo

    a = _A_ref(A_x, A_wqkv, A_wo)
    b = _B_ref(B_x, B_wqkv, B_wo)
    return torch.concatenate([a, b], axis=-1)
```

```asm
; @launch grid=(256,1,1) block=(512,1,1) lds=163840
.amdgcn_target "amdgcn-amd-amdhsa--gfx950"
.text
.globl concat_heads__softmax_full_mha__mha_block__prompt_kernel
.p2align 8
.type concat_heads__softmax_full_mha__mha_block__prompt_kernel,@function
concat_heads__softmax_full_mha__mha_block__prompt_kernel:
    s_cmp_ge_u32 s2, 256
    s_cbranch_scc1 LF_end
    s_bfe_u32 s61, s2, 0x10002
    s_mul_i32 s47, s61, 24
    s_load_dwordx2 s[8:9], s[0:1], s47
    s_add_u32 s48, s47, 8
    s_load_dwordx4 s[28:31], s[0:1], s48
    s_load_dwordx4 s[32:35], s[0:1], 48
    s_load_dwordx2 s[16:17], s[0:1], 64
    v_lshrrev_b32 v1, 6, v0
    v_and_b32 v0, 63, v0
    v_readfirstlane_b32 s40, v1
    s_cmp_lt_u32 s40, 4
    s_cbranch_scc0 LF_nt
    s_mul_i32 s48, s40, 819196
    s_cmp_lt_u32 s2, 32
    s_waitcnt lgkmcnt(0)
    s_cbranch_scc0 LF_nt
    s_load_dword s6, s[8:9], s48
    s_load_dword s7, s[28:29], s48
    s_mov_b32 s48, 22675452
    s_load_dword s6, s[16:17], s48
    s_load_dword s7, s[34:35], 0
LF_nt:
    s_and_b32 s47, s2, 3
    s_lshl_b32 s47, s47, 2
    s_bfe_u32 s49, s2, 0x20003
    s_add_u32 s46, s47, s49
    s_lshr_b32 s45, s2, 5
    s_cmp_eq_u32 s40, 7
    s_cbranch_scc0 LG_nocw
    s_getpc_b64 s[4:5]
LG_pc:
    s_sub_u32 s4, s4, LG_pc-concat_heads__softmax_full_mha__mha_block__prompt_kernel
    s_subb_u32 s5, s5, 0
    s_lshl_b32 s47, s49, 13
    v_lshl_add_u32 v8, v0, 7, s47
    v_min_u32 v8, LF_codeend-concat_heads__softmax_full_mha__mha_block__prompt_kernel-4, v8
    global_load_dword v190, v8, s[4:5]
LG_nocw:
    s_lshl_b32 s96, s45, 1
    s_cmp_ge_u32 s45, 5
    s_cselect_b32 s47, 10, 5
    s_cmp_ge_u32 s45, 3
    s_cselect_b32 s47, s47, 0
    s_add_u32 s96, s96, s47
    s_cmp_eq_u32 s45, 2
    s_cselect_b32 s47, 6, 1
    s_add_u32 s97, s96, s47
    s_and_b32 s41, s40, 3
    s_lshr_b32 s42, s40, 2
    s_cbranch_scc1 LG_start
    v_lshrrev_b32 v5, 3, v0
    v_mul_u32_u24 v5, 1280, v5
    v_and_b32 v6, 7, v0
    v_lshrrev_b32 v7, 4, v0
    v_xor_b32 v6, v6, v7
    v_lshlrev_b32 v6, 4, v6
    v_add_u32 v230, v5, v6
    v_xor_b32 v6, 64, v6
    v_add_u32 v231, v5, v6
    v_add_u32 v231, 9216, v231
    v_lshrrev_b32 v5, 2, v0
    v_and_b32 v5, 3, v5
    v_xor_b32 v5, v5, v7
    v_lshrrev_b32 v6, 1, v5
    s_sub_u32 s47, s97, s96
    s_lshl_b32 s47, s47, 7
    v_mul_u32_u24 v6, s47, v6
    v_and_b32 v5, 1, v5
    v_lshl_add_u32 v5, v5, 6, v6
    v_and_b32 v6, 3, v0
    v_lshl_add_u32 v5, v6, 4, v5
    v_mul_u32_u24 v6, 3840, v7
    v_add_u32 v232, v5, v6
    v_xor_b32 v235, 32, v232
    s_lshl_b32 s56, s46, 2
    s_add_u32 s56, s56, s41
    s_mul_i32 s56, s56, 40960
    s_mul_i32 s57, s41, 61440
    s_lshl_b32 s47, s96, 7
    s_add_u32 s57, s57, s47
    s_lshl_b32 s55, s41, 12
    s_xor_b32 s54, s46, s45
    s_and_b32 s54, s54, 1
    s_mul_i32 s54, s54, 5
    s_mov_b32 s53, s54
    s_mov_b32 s52, 0
    s_mov_b32 s10, 2621440
    s_mov_b32 s11, 0x00020000
    s_mov_b32 s14, 2457600
    s_mov_b32 s15, 0x00020000
    s_and_b32 s9, s9, 0xffff
    s_mov_b32 s12, s28
    s_and_b32 s13, s29, 0xffff
    s_branch LL_go
LL_X:
    s_lshl_b32 s47, s54, 7
    s_add_u32 s47, s47, s56
    s_add_u32 s54, s54, 1
    buffer_load_dwordx4 v230, s[8:11], s47 offen lds
    buffer_load_dwordx4 v231, s[8:11], s47 offen offset:1024 lds
    s_add_u32 m0, m0, 2048
    s_add_u32 s47, s47, 20480
    buffer_load_dwordx4 v230, s[8:11], s47 offen lds
    buffer_load_dwordx4 v231, s[8:11], s47 offen offset:1024 lds
    s_cmp_eq_u32 s54, 10
    s_cselect_b32 s54, 0, s54
    s_setpc_b64 s[62:63]
LL_Wskip:
    s_waitcnt vmcnt(0)
    s_setpc_b64 s[62:63]
LL_W:
    s_cmp_eq_u32 s52, 1
    s_cbranch_scc1 LL_Wskip
    s_mul_i32 s48, s53, 245760
    s_add_u32 s48, s48, s57
    s_add_u32 s53, s53, 1
    buffer_load_dwordx4 v232, s[12:15], s48 offen lds
    s_add_u32 m0, m0, 1024
    s_add_u32 s48, s48, 15360
    buffer_load_dwordx4 v232, s[12:15], s48 offen lds
    s_add_u32 m0, m0, 1024
    s_add_u32 s48, s48, 15360
    buffer_load_dwordx4 v235, s[12:15], s48 offen lds
    s_add_u32 m0, m0, 1024
    s_add_u32 s48, s48, 15360
    buffer_load_dwordx4 v235, s[12:15], s48 offen lds
    s_cmp_eq_u32 s53, 10
    s_cselect_b32 s53, 0, s53
    s_setpc_b64 s[62:63]
LL_go:
    s_add_u32 m0, s55, 114688
    s_call_b64 s[62:63], LL_X
    s_add_u32 m0, s55, 131072
    s_call_b64 s[62:63], LL_W
    s_lshr_b32 s47, s2, 3
    s_lshl_b32 s47, s47, 20
    s_cmp_eq_u32 s41, 1
    s_cbranch_scc0 LL_t1
    s_min_u32 s48, s47, 22675452
    s_load_dword s6, s[16:17], s48
LL_t1:
    s_cmp_eq_u32 s41, 2
    s_cbranch_scc0 LL_t2
    s_min_u32 s48, s47, 5242876
    s_load_dword s7, s[32:33], s48
    s_min_u32 s48, s47, 819196
    s_load_dword s7, s[30:31], s48
    s_load_dword s6, s[34:35], 0
LL_t2:
    s_add_u32 m0, s55, 147456
    s_call_b64 s[62:63], LL_X
    s_add_u32 m0, s55, 81920
    s_call_b64 s[62:63], LL_W
    s_add_u32 m0, s55, 98304
    s_call_b64 s[62:63], LL_X
    s_waitcnt vmcnt(12)
    s_barrier
    s_mov_b32 s51, 640
    s_add_u32 m0, s55, 0
    s_call_b64 s[62:63], LL_W
    s_add_u32 m0, s55, 16384
    s_call_b64 s[62:63], LL_X
    s_waitcnt vmcnt(12)
    s_barrier
    s_mov_b32 s51, 640
    s_add_u32 m0, s55, 32768
    s_call_b64 s[62:63], LL_W
    s_add_u32 m0, s55, 49152
    s_call_b64 s[62:63], LL_X
    s_waitcnt vmcnt(12)
    s_barrier
    s_mov_b32 s51, 640
    s_add_u32 m0, s55, 65536
    s_call_b64 s[62:63], LL_W
    s_add_u32 m0, s55, 114688
    s_call_b64 s[62:63], LL_X
    s_waitcnt vmcnt(12)
    s_barrier
    s_mov_b32 s51, 640
    s_add_u32 m0, s55, 131072
    s_call_b64 s[62:63], LL_W
    s_add_u32 m0, s55, 147456
    s_call_b64 s[62:63], LL_X
    s_lshr_b32 s47, s2, 3
    s_lshl_b32 s47, s47, 2
    s_and_b32 s48, s2, 3
    s_add_u32 s47, s47, s48
    s_mul_i32 s47, s47, 19200
    s_mul_i32 s48, s41, 19
    v_add_u32 v8, s48, v0
    v_min_u32 v8, 74, v8
    v_mul_u32_u24 v9, 205, v8
    v_lshrrev_b32 v9, 10, v9
    v_mul_u32_u24 v9, 5, v9
    v_add3_u32 v9, v9, v8, 5
    v_lshlrev_b32 v234, 7, v9
    s_mov_b64 exec, 0x7ffff
    buffer_load_dword v188, v234, s[12:15], s47 offen
    s_mov_b64 exec, -1
    s_waitcnt vmcnt(13)
    s_barrier
    s_mov_b32 s51, 640
    s_add_u32 m0, s55, 81920
    s_call_b64 s[62:63], LL_W
    s_add_u32 m0, s55, 98304
    s_call_b64 s[62:63], LL_X
    s_waitcnt vmcnt(13)
    s_barrier
    s_mov_b32 s51, 640
    s_add_u32 m0, s55, 0
    s_call_b64 s[62:63], LL_W
    s_add_u32 m0, s55, 16384
    s_call_b64 s[62:63], LL_X
    s_waitcnt vmcnt(12)
    s_barrier
    s_mov_b32 s51, 640
    s_add_u32 m0, s55, 32768
    s_call_b64 s[62:63], LL_W
    s_add_u32 m0, s55, 49152
    s_call_b64 s[62:63], LL_X
    s_waitcnt vmcnt(12)
    s_barrier
    s_mov_b32 s51, 640
    s_add_u32 m0, s55, 65536
    s_call_b64 s[62:63], LL_W
    s_cmp_ge_u32 s45, 5
    s_cselect_b32 s47, 768, s51
    s_add_u32 s57, s57, s47
    s_cmp_eq_u32 s45, 7
    s_cselect_b32 s52, 1, 0
    s_add_u32 m0, s55, 114688
    s_call_b64 s[62:63], LL_W
    s_add_u32 m0, s55, 131072
    s_call_b64 s[62:63], LL_W
    s_waitcnt vmcnt(16)
    s_barrier
    s_mov_b32 s51, 640
    s_add_u32 m0, s55, 147456
    s_call_b64 s[62:63], LL_W
    s_add_u32 m0, s55, 81920
    s_call_b64 s[62:63], LL_W
    s_add_u32 m0, s55, 98304
    s_call_b64 s[62:63], LL_W
    s_and_b32 s47, s2, 1
    s_lshl_b32 s47, s47, 3
    s_and_b32 s48, s2, 2
    s_lshl_b32 s48, s48, 1
    s_add_u32 s47, s47, s48
    s_lshr_b32 s49, s2, 6
    s_add_u32 s43, s47, s49
    s_lshr_b32 s44, s2, 3
    s_and_b32 s44, s44, 7
    s_lshl_b32 s49, s42, 4
    s_add_u32 s43, s43, s49
    s_mul_i32 s98, s61, 10485760
    s_mov_b32 s99, 0
    s_mov_b32 s18, 22675456
    s_mov_b32 s19, 0x00020000
    s_mov_b32 s22, 5242880
    s_mov_b32 s23, 0x00020000
    s_mov_b32 s26, 256
    s_mov_b32 s27, 0x00020000
    s_waitcnt lgkmcnt(0)
    s_mov_b32 s20, s32
    s_and_b32 s21, s33, 0xffff
    s_mov_b32 s24, s34
    s_and_b32 s25, s35, 0xffff
    s_and_b32 s17, s17, 0xffff
    v_lshlrev_b32 v187, 2, v0
    v_or_b32 v187, 12, v187
    v_mov_b32 v233, s41
    s_cmp_eq_u32 s41, 0
    s_cbranch_scc0 LL_nc
    buffer_load_dword v233, v187, s[24:27], 0 offen sc1
LL_nc:
    s_waitcnt vmcnt(20)
    s_barrier
    s_mov_b32 s51, 640
    s_add_u32 m0, s55, 0
    s_call_b64 s[62:63], LL_W
    s_add_u32 m0, s55, 16384
    s_call_b64 s[62:63], LL_W
    s_waitcnt vmcnt(24)
    s_barrier
    s_mov_b32 s51, 640
    v_mov_b32 v182, 0
    v_mov_b32 v184, 32768
    ds_write_b32 v184, v182
    s_waitcnt lgkmcnt(0)
    s_waitcnt vmcnt(4)
    v_cmp_gt_u32 vcc, 1, v233
    s_cbranch_vccz LL_cnt_ok
    s_mov_b32 s60, 262144
LF_poll1:
    buffer_load_dword v188, v187, s[24:27], 0 offen sc1
    s_waitcnt vmcnt(0)
    v_cmp_gt_u32 vcc, 1, v188
    s_cbranch_vccz LF_poll1_ok
    s_sleep 2
    s_sub_u32 s60, s60, 1
    s_cbranch_scc0 LF_poll1
LF_poll1_ok:
LL_cnt_ok:
    s_barrier
    s_mul_i32 s58, s43, 5
    s_add_u32 s58, s58, 1
    s_lshr_b32 s58, s58, 1
    s_lshl_b32 s58, s58, 9
    s_and_b32 s47, s43, 1
    s_mov_b32 s48, 1024
    s_cselect_b32 s48, 4294966792, s48
    s_add_u32 s59, s58, s48
    s_min_u32 s47, s58, s59
    s_add_u32 s49, s58, 512
    s_max_u32 s48, s59, s49
    s_lshr_b32 s47, s47, 12
    s_lshr_b32 s48, s48, 12
    s_cmp_eq_u32 s47, s48
    s_cselect_b32 s3, 16, 32
    s_and_b32 s47, s43, 1
    v_lshlrev_b32 v15, 4, v0
    v_lshrrev_b32 v3, 5, v0
    v_mul_u32_u24 v14, 40960, v3
    v_and_b32 v182, 31, v0
    v_lshl_add_u32 v46, v182, 4, v14
    s_lshl_b32 s47, s47, 2
    v_and_b32 v183, 3, v0
    v_and_b32 v184, 4, v0
    v_lshl_add_u32 v183, v184, 1, v183
    v_and_b32 v184, 8, v0
    v_lshrrev_b32 v184, 1, v184
    v_add3_u32 v183, v183, v184, s47
    s_lshl_b32 s47, s47, 2
    v_subrev_u32 v184, s47, v182
    v_cmp_gt_u32 vcc, 16, v182
    v_mul_u32_u24 v14, 10240, v3
    v_mul_u32_u24 v3, 320, v3
    v_cndmask_b32 v183, v184, v183, vcc
    v_lshlrev_b32 v183, 4, v183
    v_add_u32 v47, v183, v14
    v_add_u32 v44, v183, v3
    v_add_u32 v44, 6144, v44
    v_cmp_gt_u32 vcc, 20, v182
    v_mov_b32 v183, 0x100000
    v_mov_b32 v184, 90112
    v_cndmask_b32 v45, 0, 1, vcc
    v_cndmask_b32 v44, v183, v44, vcc
    v_cmp_eq_u32 vcc, 20, v182
    v_cmp_eq_u32 s[50:51], 24, v182
    s_or_b64 vcc, vcc, s[50:51]
    v_mov_b32 v183, 0
    s_nop 0
    v_cndmask_b32 v248, v44, v183, vcc
    v_cndmask_b32 v44, v44, v184, vcc
    s_and_b32 s47, s41, 1
    s_cbranch_scc1 LA_dv
    v_add_u32 v176, s59, v46
    v_add_u32 v177, 81920, v176
    v_add_u32 v178, s58, v15
    v_add_u32 v179, 40960, v178
    v_add_u32 v180, 40960, v179
    v_add_u32 v181, 40960, v180
    s_branch LA_dd
LA_dv:
    s_mul_i32 s47, s43, 320
    s_add_u32 s47, s47, 2621440
    v_add_u32 v182, 0, v0
    v_mul_u32_u24 v183, 3277, v182
    v_lshrrev_b32 v183, 16, v183
    v_mul_u32_u24 v184, 20, v183
    v_sub_u32 v184, v182, v184
    v_mul_u32_u24 v183, 10240, v183
    v_lshl_add_u32 v183, v184, 4, v183
    v_add_u32 v176, s47, v183
    v_add_u32 v182, 64, v0
    v_mul_u32_u24 v183, 3277, v182
    v_lshrrev_b32 v183, 16, v183
    v_mul_u32_u24 v184, 20, v183
    v_sub_u32 v184, v182, v184
    v_mul_u32_u24 v183, 10240, v183
    v_lshl_add_u32 v183, v184, 4, v183
    v_add_u32 v177, s47, v183
    v_add_u32 v182, 128, v0
    v_mul_u32_u24 v183, 3277, v182
    v_lshrrev_b32 v183, 16, v183
    v_mul_u32_u24 v184, 20, v183
    v_sub_u32 v184, v182, v184
    v_mul_u32_u24 v183, 10240, v183
    v_lshl_add_u32 v183, v184, 4, v183
    v_add_u32 v178, s47, v183
    v_add_u32 v182, 192, v0
    v_mul_u32_u24 v183, 3277, v182
    v_lshrrev_b32 v183, 16, v183
    v_mul_u32_u24 v184, 20, v183
    v_sub_u32 v184, v182, v184
    v_mul_u32_u24 v183, 10240, v183
    v_lshl_add_u32 v183, v184, 4, v183
    v_add_u32 v179, s47, v183
    v_add_u32 v182, 256, v0
    v_mul_u32_u24 v183, 3277, v182
    v_lshrrev_b32 v183, 16, v183
    v_mul_u32_u24 v184, 20, v183
    v_sub_u32 v184, v182, v184
    v_mul_u32_u24 v183, 10240, v183
    v_lshl_add_u32 v183, v184, 4, v183
    v_add_u32 v180, s47, v183
    v_mov_b32 v181, v180
LA_dd:
    v_lshlrev_b32 v185, 7, v0
    v_mov_b32 v186, 0
    v_add_u32 v205, 0, v0
    v_mul_u32_u24 v206, 3277, v205
    v_lshrrev_b32 v206, 16, v206
    v_mul_u32_u24 v207, 20, v206
    v_sub_u32 v207, v205, v207
    v_mul_u32_u24 v206, 1280, v206
    v_lshl_add_u32 v194, v207, 4, v206
    v_add_u32 v205, 64, v0
    v_mul_u32_u24 v206, 3277, v205
    v_lshrrev_b32 v206, 16, v206
    v_mul_u32_u24 v207, 20, v206
    v_sub_u32 v207, v205, v207
    v_mul_u32_u24 v206, 1280, v206
    v_lshl_add_u32 v195, v207, 4, v206
    v_add_u32 v205, 128, v0
    v_mul_u32_u24 v206, 3277, v205
    v_lshrrev_b32 v206, 16, v206
    v_mul_u32_u24 v207, 20, v206
    v_sub_u32 v207, v205, v207
    v_mul_u32_u24 v206, 1280, v206
    v_lshl_add_u32 v196, v207, 4, v206
    v_add_u32 v205, 192, v0
    v_mul_u32_u24 v206, 3277, v205
    v_lshrrev_b32 v206, 16, v206
    v_mul_u32_u24 v207, 20, v206
    v_sub_u32 v207, v205, v207
    v_mul_u32_u24 v206, 1280, v206
    v_lshl_add_u32 v197, v207, 4, v206
    v_add_u32 v205, 256, v0
    v_mul_u32_u24 v206, 3277, v205
    v_lshrrev_b32 v206, 16, v206
    v_mul_u32_u24 v207, 20, v206
    v_sub_u32 v207, v205, v207
    v_mul_u32_u24 v206, 1280, v206
    v_lshl_add_u32 v198, v207, 4, v206
    v_and_b32 v205, 48, v0
    v_lshlrev_b32 v205, 4, v205
    v_add_u32 v205, 72704, v205
    v_and_b32 v206, 7, v0
    v_mul_u32_u24 v206, 1040, v206
    v_and_b32 v207, 8, v0
    v_lshl_add_u32 v206, v207, 1, v206
    v_add_u32 v201, v205, v206
    v_and_b32 v206, 1, v0
    v_mul_u32_u24 v206, 1040, v206
    v_and_b32 v207, 14, v0
    v_lshl_add_u32 v206, v207, 3, v206
    v_add3_u32 v202, v205, v206, 0
    v_lshrrev_b32 v205, 4, v0
    v_lshlrev_b32 v205, 3, v205
    v_lshrrev_b32 v206, 2, v0
    v_and_b32 v206, 3, v206
    v_add_u32 v205, v205, v206
    v_mul_u32_u24 v205, 320, v205
    v_and_b32 v206, 3, v0
    v_lshl_add_u32 v205, v206, 3, v205
    v_add_u32 v205, 72704, v205
    s_and_b32 s47, s2, 2
    s_cselect_b32 s47, 64, 0
    s_cselect_b32 s48, 0, 256
    v_add_u32 v199, s47, v205
    v_add_u32 v200, s48, v205
    v_add_u32 v205, 72704, v15
    v_mov_b32 v184, 32768
    s_cmp_lg_u32 s41, 0
    s_cbranch_scc1 LL_pub
    s_mov_b32 s60, 2097152
LL_try:
    ds_read_b32 v182, v184
    s_waitcnt lgkmcnt(0)
    v_readfirstlane_b32 s47, v182
    s_cmp_eq_u32 s47, 16
    s_cbranch_scc1 LL_try_go
    s_sub_u32 s60, s60, 1
    s_cbranch_scc0 LL_try
LL_try_go:
    s_call_b64 s[62:63], LG_publish
LL_pub:
    s_mov_b32 s51, 640
    s_add_u32 m0, s55, 32768
    s_call_b64 s[62:63], LL_W
    s_add_u32 m0, s55, 49152
    s_call_b64 s[62:63], LL_W
    s_add_u32 m0, s55, 65536
    s_call_b64 s[62:63], LL_W
    s_lshr_b32 s38, s2, 3
    s_lshl_b32 s38, s38, 1
    s_bfe_u32 s47, s2, 0x10001
    s_add_u32 s38, s38, s47
    s_mov_b32 s39, 0
    s_and_b32 s47, s2, 1
    s_cselect_b32 s47, 0, s41
    s_cmp_eq_u32 s47, 1
    s_cselect_b32 s96, 3, -1
    s_mov_b32 s56, 0
    s_mov_b32 s57, 0
    s_mov_b32 s53, 96256
    s_mov_b32 s52, 118784
    v_pk_mov_b32 v[40:41], 0, 0
    v_pk_mov_b32 v[42:43], 0, 0
    v_pk_mov_b32 v[136:137], 0, 0
    v_pk_mov_b32 v[138:139], 0, 0
    v_pk_mov_b32 v[140:141], 0, 0
    v_pk_mov_b32 v[142:143], 0, 0
    v_mov_b32 v182, 0xbf803f80
    v_mov_b32 v183, 0
    v_mov_b32 v189, 0
    v_mfma_f32_32x32x4_2b_bf16 v[144:175], v[40:41], v[40:41], 0
    s_add_u32 s54, s53, 67584
    s_mov_b32 s55, 7
    v_mov_b32 v192, 0xdddddddd
    v_lshrrev_b32 v193, 1, v15
    v_xor_b32 v193, v193, v15
    v_and_b32 v193, 64, v193
    v_mul_u32_u24 v193, 3, v193
    v_xor_b32 v193, v193, v15
    v_add_u32 v1, s52, v193
    v_mad_u32_u24 v2, v45, s52, v44
    s_lshl_b32 s47, s44, 2
    s_add_u32 s47, s47, s41
    s_mul_i32 s37, s47, 81920
    s_add_u32 s37, s37, s98
    s_add_u32 s37, s37, 7864320
    s_lshr_b32 s48, s43, 3
    s_max_u32 s48, s48, 1
    s_sub_u32 s48, s48, 1
    s_lshl_b32 s97, s61, 5
    s_add_u32 s97, s97, s47
    s_mul_i32 s97, s97, 3
    s_add_u32 s97, s97, s48
    s_lshl_b32 s97, s97, 7
    s_add_u32 s97, s97, 22642688
    s_sub_u32 s47, s37, 7864320
    s_add_u32 s8,  s47, s58
    s_add_u32 s9, s8,  40960
    s_add_u32 s10, s47, s59
    s_lshr_b32 s50, s41, 1
    s_mul_i32 s48, s50, 163840
    s_add_u32 s48, s48, s98
    s_add_u32 s48, s48, 2621440
    s_and_b32 s12, s43, 7
    s_mul_i32 s11, s12, 327680
    s_add_u32 s11, s11, s48
    s_add_u32 s12, s12, 1
    s_and_b32 s12, s12, 7
    s_mul_i32 s12, s12, 327680
    s_add_u32 s12, s12, s48
    s_mul_i32 s13, s50, 11264
    s_and_b32 s14, s41, 1
    s_mul_i32 s51, s14, 6144
    s_add_u32 s13, s13, s51
    s_add_u32 m0, s13, 118784
    s_lshl_b32 s15, s61, 5
    s_add_u32 s15, s15, s43
    s_lshl_b32 s15, s15, 9
    s_add_u32 s15, s15, 22609920
    s_waitcnt vmcnt(0)
    s_barrier
    s_mov_b32 s51, 640
    s_branch LA_lead
LG_start:
    s_and_b32 s47, s2, 1
    s_lshl_b32 s47, s47, 3
    s_and_b32 s48, s2, 2
    s_lshl_b32 s48, s48, 1
    s_add_u32 s47, s47, s48
    s_lshr_b32 s49, s2, 6
    s_add_u32 s43, s47, s49
    s_lshr_b32 s44, s2, 3
    s_and_b32 s44, s44, 7
    s_lshl_b32 s49, s42, 4
    s_add_u32 s43, s43, s49
    s_mul_i32 s98, s61, 10485760
    s_mov_b32 s99, 0
    s_mov_b32 s18, 22675456
    s_mov_b32 s19, 0x00020000
    s_mov_b32 s22, 5242880
    s_mov_b32 s23, 0x00020000
    s_mov_b32 s26, 256
    s_mov_b32 s27, 0x00020000
    s_waitcnt lgkmcnt(0)
    s_mov_b32 s20, s32
    s_and_b32 s21, s33, 0xffff
    s_mov_b32 s24, s34
    s_and_b32 s25, s35, 0xffff
    s_and_b32 s17, s17, 0xffff
    v_and_b32 v8, 15, v0
    v_lshrrev_b32 v9, 4, v0
    v_lshrrev_b32 v10, 2, v0
    v_and_b32 v10, 3, v10
    v_lshl_add_u32 v11, v9, 3, v10
    v_lshlrev_b32 v11, 8, v11
    v_lshl_add_u32 v11, v10, 6, v11
    v_and_b32 v10, 16, v0
    v_lshl_add_u32 v11, v10, 1, v11
    v_and_b32 v10, 3, v0
    v_lshl_add_u32 v11, v10, 3, v11
    v_add_u32 v184, 131072, v11
    v_xor_b32 v185, 64, v184
    v_xor_b32 v186, 128, v184
    v_xor_b32 v187, 192, v184
    s_lshl_b32 s48, s41, 12
    s_add_u32 s48, s48, 114688
    s_lshl_b32 s47, s46, 2
    s_add_u32 s47, s47, s41
    s_mul_i32 s47, s47, 40960
    s_add_u32 s47, s47, s98
    s_cmp_ge_u32 s45, 5
    s_cbranch_scc1 LG_vtype
    v_lshrrev_b32 v10, 1, v8
    v_xor_b32 v10, v10, v9
    v_lshlrev_b32 v10, 4, v10
    v_lshl_add_u32 v10, v8, 7, v10
    v_add_u32 v188, s48, v10
    v_and_b32 v10, 1, v9
    v_lshlrev_b32 v10, 10, v10
    v_lshrrev_b32 v11, 1, v9
    v_lshl_add_u32 v10, v11, 9, v10
    v_lshl_add_u32 v189, v8, 4, v10
    s_lshl_b32 s56, s96, 12
    s_lshl_b32 s57, s97, 12
    s_cmp_ge_u32 s96, 10
    s_cselect_b32 s50, 2580480, 0
    s_add_u32 s56, s56, s50
    s_cmp_ge_u32 s97, 10
    s_cselect_b32 s50, 2580480, 0
    s_add_u32 s57, s57, s50
    s_add_u32 s56, s56, s47
    s_add_u32 s57, s57, s47
    s_barrier
    s_mov_b32 s36, 1
    v_xor_b32 v8, 64, v188
    ds_read_b128 v[0:3], v188 offset:0
    ds_read_b128 v[4:7], v188 offset:2048
    ds_read_b128 v[12:15], v8 offset:2048
    ds_read_b128 v[8:11], v8 offset:0
    ds_read_b64_tr_b16 v[162:163], v184 offset:1024
    ds_read_b64_tr_b16 v[160:161], v184 offset:0
    v_xor_b32 v191, 32, v184
    ds_read_b64_tr_b16 v[166:167], v191 offset:1024
    ds_read_b64_tr_b16 v[164:165], v191 offset:0
    ds_read_b64_tr_b16 v[170:171], v185 offset:1024
    ds_read_b64_tr_b16 v[168:169], v185 offset:0
    v_xor_b32 v191, 32, v185
    ds_read_b64_tr_b16 v[174:175], v191 offset:1024
    ds_read_b64_tr_b16 v[172:173], v191 offset:0
    ds_read_b64_tr_b16 v[178:179], v186 offset:1024
    ds_read_b64_tr_b16 v[176:177], v186 offset:0
    v_xor_b32 v191, 32, v186
    ds_read_b64_tr_b16 v[182:183], v191 offset:1024
LG_q_body:
    s_waitcnt lgkmcnt(9)
    v_mfma_f32_16x16x32_bf16 v[192:195], v[160:163], v[0:3], 0
    s_cmp_eq_u32 s99, 1
    ds_read_b64_tr_b16 v[180:181], v191 offset:0
    v_mfma_f32_16x16x32_bf16 v[200:203], v[160:163], v[4:7], 0
    s_waitcnt lgkmcnt(8)
    ds_read_b64_tr_b16 v[162:163], v187 offset:1024
    v_xor_b32 v191, 32, v187
    v_mfma_f32_16x16x32_bf16 v[196:199], v[164:167], v[0:3], 0
    s_mov_b32 s55, 4294918144
    ds_read_b64_tr_b16 v[160:161], v187 offset:0
    v_mfma_f32_16x16x32_bf16 v[204:207], v[164:167], v[4:7], 0
    s_waitcnt lgkmcnt(8)
    ds_read_b64_tr_b16 v[166:167], v191 offset:1024
    v_mfma_f32_16x16x32_bf16 v[208:211], v[168:171], v[0:3], 0
    s_cmov_b32 s55, 16384
    ds_read_b64_tr_b16 v[164:165], v191 offset:0
    v_mfma_f32_16x16x32_bf16 v[216:219], v[168:171], v[4:7], 0
    s_waitcnt lgkmcnt(8)
    ds_read_b64_tr_b16 v[170:171], v184 offset:9216
    v_xor_b32 v191, 32, v184
    v_mfma_f32_16x16x32_bf16 v[212:215], v[172:175], v[0:3], 0
    ds_read_b64_tr_b16 v[168:169], v184 offset:8192
    v_mfma_f32_16x16x32_bf16 v[220:223], v[172:175], v[4:7], 0
    s_waitcnt lgkmcnt(8)
    ds_read_b64_tr_b16 v[174:175], v191 offset:9216
    v_add_u32 v184, s55, v184
    v_mfma_f32_16x16x32_bf16 v[224:227], v[176:179], v[0:3], 0
    ds_read_b64_tr_b16 v[172:173], v191 offset:8192
    v_mfma_f32_16x16x32_bf16 v[232:235], v[176:179], v[4:7], 0
    s_waitcnt lgkmcnt(8)
    ds_read_b64_tr_b16 v[178:179], v185 offset:9216
    v_xor_b32 v191, 32, v185
    v_mfma_f32_16x16x32_bf16 v[228:231], v[180:183], v[0:3], 0
    ds_read_b64_tr_b16 v[176:177], v185 offset:8192
    v_mfma_f32_16x16x32_bf16 v[236:239], v[180:183], v[4:7], 0
    s_waitcnt lgkmcnt(8)
    ds_read_b64_tr_b16 v[182:183], v191 offset:9216
    v_add_u32 v185, s55, v185
    v_mfma_f32_16x16x32_bf16 v[240:243], v[160:163], v[0:3], 0
    ds_read_b64_tr_b16 v[180:181], v191 offset:8192
    v_mfma_f32_16x16x32_bf16 v[248:251], v[160:163], v[4:7], 0
    s_waitcnt lgkmcnt(8)
    ds_read_b64_tr_b16 v[162:163], v186 offset:9216
    v_xor_b32 v191, 32, v186
    v_mfma_f32_16x16x32_bf16 v[244:247], v[164:167], v[0:3], 0
    ds_read_b64_tr_b16 v[160:161], v186 offset:8192
    v_mfma_f32_16x16x32_bf16 v[252:255], v[164:167], v[4:7], 0
    s_waitcnt lgkmcnt(8)
    ds_read_b64_tr_b16 v[166:167], v191 offset:9216
    v_add_u32 v186, s55, v186
    v_mfma_f32_16x16x32_bf16 v[192:195], v[168:171], v[8:11], v[192:195]
    ds_read_b64_tr_b16 v[164:165], v191 offset:8192
    v_mfma_f32_16x16x32_bf16 v[200:203], v[168:171], v[12:15], v[200:203]
    s_waitcnt lgkmcnt(8)
    ds_read_b64_tr_b16 v[170:171], v187 offset:9216
    v_xor_b32 v191, 32, v187
    v_mfma_f32_16x16x32_bf16 v[196:199], v[172:175], v[8:11], v[196:199]
    ds_read_b64_tr_b16 v[168:169], v187 offset:8192
    v_mfma_f32_16x16x32_bf16 v[204:207], v[172:175], v[12:15], v[204:207]
    s_waitcnt lgkmcnt(8)
    ds_read_b64_tr_b16 v[174:175], v191 offset:9216
    v_add_u32 v187, s55, v187
    v_mfma_f32_16x16x32_bf16 v[208:211], v[176:179], v[8:11], v[208:211]
    ds_read_b64_tr_b16 v[172:173], v191 offset:8192
    v_mfma_f32_16x16x32_bf16 v[216:219], v[176:179], v[12:15], v[216:219]
    s_waitcnt lgkmcnt(8)
    s_barrier
    s_cbranch_scc0 LG_q_xa0
LG_q_xb0:
    ds_read_b64_tr_b16 v[178:179], v184 offset:1024
    v_xor_b32 v191, 32, v184
    v_mfma_f32_16x16x32_bf16 v[212:215], v[180:183], v[8:11], v[212:215]
    ds_read_b64_tr_b16 v[176:177], v184 offset:0
    v_mfma_f32_16x16x32_bf16 v[220:223], v[180:183], v[12:15], v[220:223]
    s_waitcnt lgkmcnt(8)
    ds_read_b64_tr_b16 v[182:183], v191 offset:1024
    v_mfma_f32_16x16x32_bf16 v[224:227], v[160:163], v[8:11], v[224:227]
    s_getreg_b32 s47, hwreg(HW_REG_IB_STS, 0, 4)
    ds_read_b64_tr_b16 v[180:181], v191 offset:0
    v_mfma_f32_16x16x32_bf16 v[232:235], v[160:163], v[12:15], v[232:235]
    s_waitcnt lgkmcnt(8)
    ds_read_b64_tr_b16 v[162:163], v185 offset:1024
    v_xor_b32 v191, 32, v185
    v_mfma_f32_16x16x32_bf16 v[228:231], v[164:167], v[8:11], v[228:231]
    s_or_b32 s47, s47, s36
    ds_read_b64_tr_b16 v[160:161], v185 offset:0
    v_mfma_f32_16x16x32_bf16 v[236:239], v[164:167], v[12:15], v[236:239]
    s_waitcnt lgkmcnt(8)
    ds_read_b64_tr_b16 v[166:167], v191 offset:1024
    v_mfma_f32_16x16x32_bf16 v[240:243], v[168:171], v[8:11], v[240:243]
    s_cbranch_scc0 LG_q_da0
LG_q_db0:
    ds_read_b64_tr_b16 v[164:165], v191 offset:0
    v_mfma_f32_16x16x32_bf16 v[248:251], v[168:171], v[12:15], v[248:251]
    s_waitcnt lgkmcnt(8)
    ds_read_b64_tr_b16 v[170:171], v186 offset:1024
    v_xor_b32 v191, 32, v186
    v_mfma_f32_16x16x32_bf16 v[244:247], v[172:175], v[8:11], v[244:247]
    ds_read_b64_tr_b16 v[168:169], v186 offset:0
    v_mfma_f32_16x16x32_bf16 v[252:255], v[172:175], v[12:15], v[252:255]
    s_waitcnt lgkmcnt(8)
    ds_read_b64_tr_b16 v[174:175], v191 offset:1024
    v_mfma_f32_16x16x32_bf16 v[192:195], v[176:179], v[16:19], v[192:195]
    s_cmp_eq_u32 s99, 1
    ds_read_b64_tr_b16 v[172:173], v191 offset:0
    v_mfma_f32_16x16x32_bf16 v[200:203], v[176:179], v[20:23], v[200:203]
    s_waitcnt lgkmcnt(8)
    ds_read_b64_tr_b16 v[178:179], v187 offset:1024
    v_xor_b32 v191, 32, v187
    v_mfma_f32_16x16x32_bf16 v[196:199], v[180:183], v[16:19], v[196:199]
    s_mov_b32 s55, 4294885376
    ds_read_b64_tr_b16 v[176:177], v187 offset:0
    v_mfma_f32_16x16x32_bf16 v[204:207], v[180:183], v[20:23], v[204:207]
    s_waitcnt lgkmcnt(8)
    ds_read_b64_tr_b16 v[182:183], v191 offset:1024
    v_mfma_f32_16x16x32_bf16 v[208:211], v[160:163], v[16:19], v[208:211]
    s_cmov_b32 s55, 16384
    ds_read_b64_tr_b16 v[180:181], v191 offset:0
    v_mfma_f32_16x16x32_bf16 v[216:219], v[160:163], v[20:23], v[216:219]
    s_waitcnt lgkmcnt(8)
    ds_read_b64_tr_b16 v[162:163], v184 offset:9216
    v_xor_b32 v191, 32, v184
    v_mfma_f32_16x16x32_bf16 v[212:215], v[164:167], v[16:19], v[212:215]
    ds_read_b64_tr_b16 v[160:161], v184 offset:8192
    v_mfma_f32_16x16x32_bf16 v[220:223], v[164:167], v[20:23], v[220:223]
    s_waitcnt lgkmcnt(8)
    ds_read_b64_tr_b16 v[166:167], v191 offset:9216
    v_add_u32 v184, s55, v184
    v_mfma_f32_16x16x32_bf16 v[224:227], v[168:171], v[16:19], v[224:227]
    ds_read_b64_tr_b16 v[164:165], v191 offset:8192
    v_mfma_f32_16x16x32_bf16 v[232:235], v[168:171], v[20:23], v[232:235]
    s_waitcnt lgkmcnt(8)
    ds_read_b64_tr_b16 v[170:171], v185 offset:9216
    v_xor_b32 v191, 32, v185
    v_mfma_f32_16x16x32_bf16 v[228:231], v[172:175], v[16:19], v[228:231]
    ds_read_b64_tr_b16 v[168:169], v185 offset:8192
    v_mfma_f32_16x16x32_bf16 v[236:239], v[172:175], v[20:23], v[236:239]
    s_waitcnt lgkmcnt(8)
    ds_read_b64_tr_b16 v[174:175], v191 offset:9216
    v_add_u32 v185, s55, v185
    v_mfma_f32_16x16x32_bf16 v[240:243], v[176:179], v[16:19], v[240:243]
    ds_read_b64_tr_b16 v[172:173], v191 offset:8192
    v_mfma_f32_16x16x32_bf16 v[248:251], v[176:179], v[20:23], v[248:251]
    s_waitcnt lgkmcnt(8)
    ds_read_b64_tr_b16 v[178:179], v186 offset:9216
    v_xor_b32 v191, 32, v186
    v_mfma_f32_16x16x32_bf16 v[244:247], v[180:183], v[16:19], v[244:247]
    ds_read_b64_tr_b16 v[176:177], v186 offset:8192
    v_mfma_f32_16x16x32_bf16 v[252:255], v[180:183], v[20:23], v[252:255]
    s_waitcnt lgkmcnt(8)
    ds_read_b64_tr_b16 v[182:183], v191 offset:9216
    v_add_u32 v186, s55, v186
    v_mfma_f32_16x16x32_bf16 v[192:195], v[160:163], v[24:27], v[192:195]
    ds_read_b64_tr_b16 v[180:181], v191 offset:8192
    v_mfma_f32_16x16x32_bf16 v[200:203], v[160:163], v[28:31], v[200:203]
    s_waitcnt lgkmcnt(8)
    ds_read_b64_tr_b16 v[162:163], v187 offset:9216
    v_xor_b32 v191, 32, v187
    v_mfma_f32_16x16x32_bf16 v[196:199], v[164:167], v[24:27], v[196:199]
    ds_read_b64_tr_b16 v[160:161], v187 offset:8192
    v_mfma_f32_16x16x32_bf16 v[204:207], v[164:167], v[28:31], v[204:207]
    s_waitcnt lgkmcnt(8)
    ds_read_b64_tr_b16 v[166:167], v191 offset:9216
    v_add_u32 v187, s55, v187
    v_mfma_f32_16x16x32_bf16 v[208:211], v[168:171], v[24:27], v[208:211]
    ds_read_b64_tr_b16 v[164:165], v191 offset:8192
    v_mfma_f32_16x16x32_bf16 v[216:219], v[168:171], v[28:31], v[216:219]
    s_waitcnt lgkmcnt(8)
    s_cbranch_scc0 LG_q_xa1
LG_q_xb1:
    ds_read_b64_tr_b16 v[170:171], v184 offset:1024
    v_xor_b32 v191, 32, v184
    v_mfma_f32_16x16x32_bf16 v[212:215], v[172:175], v[24:27], v[212:215]
    ds_read_b64_tr_b16 v[168:169], v184 offset:0
    v_mfma_f32_16x16x32_bf16 v[220:223], v[172:175], v[28:31], v[220:223]
    s_waitcnt lgkmcnt(8)
    ds_read_b64_tr_b16 v[174:175], v191 offset:1024
    v_mfma_f32_16x16x32_bf16 v[224:227], v[176:179], v[24:27], v[224:227]
    s_getreg_b32 s47, hwreg(HW_REG_IB_STS, 0, 4)
    ds_read_b64_tr_b16 v[172:173], v191 offset:0
    v_mfma_f32_16x16x32_bf16 v[232:235], v[176:179], v[28:31], v[232:235]
    s_waitcnt lgkmcnt(8)
    ds_read_b64_tr_b16 v[178:179], v185 offset:1024
    v_xor_b32 v191, 32, v185
    v_mfma_f32_16x16x32_bf16 v[228:231], v[180:183], v[24:27], v[228:231]
    s_or_b32 s47, s47, s36
    ds_read_b64_tr_b16 v[176:177], v185 offset:0
    v_mfma_f32_16x16x32_bf16 v[236:239], v[180:183], v[28:31], v[236:239]
    s_waitcnt lgkmcnt(8)
    ds_read_b64_tr_b16 v[182:183], v191 offset:1024
    v_mfma_f32_16x16x32_bf16 v[240:243], v[160:163], v[24:27], v[240:243]
    s_cbranch_scc0 LG_q_da1
LG_q_db1:
    ds_read_b64_tr_b16 v[180:181], v191 offset:0
    v_mfma_f32_16x16x32_bf16 v[248:251], v[160:163], v[28:31], v[248:251]
    s_waitcnt lgkmcnt(8)
    ds_read_b64_tr_b16 v[162:163], v186 offset:1024
    v_xor_b32 v191, 32, v186
    v_mfma_f32_16x16x32_bf16 v[244:247], v[164:167], v[24:27], v[244:247]
    ds_read_b64_tr_b16 v[160:161], v186 offset:0
    v_mfma_f32_16x16x32_bf16 v[252:255], v[164:167], v[28:31], v[252:255]
    s_waitcnt lgkmcnt(8)
    ds_read_b64_tr_b16 v[166:167], v191 offset:1024
    v_mfma_f32_16x16x32_bf16 v[192:195], v[168:171], v[32:35], v[192:195]
    s_cmp_eq_u32 s99, 1
    ds_read_b64_tr_b16 v[164:165], v191 offset:0
    v_mfma_f32_16x16x32_bf16 v[200:203], v[168:171], v[36:39], v[200:203]
    s_waitcnt lgkmcnt(8)
    ds_read_b64_tr_b16 v[170:171], v187 offset:1024
    v_xor_b32 v191, 32, v187
    v_mfma_f32_16x16x32_bf16 v[196:199], v[172:175], v[32:35], v[196:199]
    s_mov_b32 s55, 32768
    ds_read_b64_tr_b16 v[168:169], v187 offset:0
    v_mfma_f32_16x16x32_bf16 v[204:207], v[172:175], v[36:39], v[204:207]
    s_waitcnt lgkmcnt(8)
    ds_read_b64_tr_b16 v[174:175], v191 offset:1024
    v_mfma_f32_16x16x32_bf16 v[208:211], v[176:179], v[32:35], v[208:211]
    s_cmov_b32 s55, 4294901760
    ds_read_b64_tr_b16 v[172:173], v191 offset:0
    v_mfma_f32_16x16x32_bf16 v[216:219], v[176:179], v[36:39], v[216:219]
    s_waitcnt lgkmcnt(8)
    ds_read_b64_tr_b16 v[178:179], v184 offset:9216
    v_xor_b32 v191, 32, v184
    v_mfma_f32_16x16x32_bf16 v[212:215], v[180:183], v[32:35], v[212:215]
    ds_read_b64_tr_b16 v[176:177], v184 offset:8192
    v_mfma_f32_16x16x32_bf16 v[220:223], v[180:183], v[36:39], v[220:223]
    s_waitcnt lgkmcnt(8)
    ds_read_b64_tr_b16 v[182:183], v191 offset:9216
    v_add_u32 v184, s55, v184
    v_mfma_f32_16x16x32_bf16 v[224:227], v[160:163], v[32:35], v[224:227]
    ds_read_b64_tr_b16 v[180:181], v191 offset:8192
    v_mfma_f32_16x16x32_bf16 v[232:235], v[160:163], v[36:39], v[232:235]
    s_waitcnt lgkmcnt(8)
    ds_read_b64_tr_b16 v[162:163], v185 offset:9216
    v_xor_b32 v191, 32, v185
    v_mfma_f32_16x16x32_bf16 v[228:231], v[164:167], v[32:35], v[228:231]
    ds_read_b64_tr_b16 v[160:161], v185 offset:8192
    v_mfma_f32_16x16x32_bf16 v[236:239], v[164:167], v[36:39], v[236:239]
    s_waitcnt lgkmcnt(8)
    ds_read_b64_tr_b16 v[166:167], v191 offset:9216
    v_add_u32 v185, s55, v185
    v_mfma_f32_16x16x32_bf16 v[240:243], v[168:171], v[32:35], v[240:243]
    ds_read_b64_tr_b16 v[164:165], v191 offset:8192
    v_mfma_f32_16x16x32_bf16 v[248:251], v[168:171], v[36:39], v[248:251]
    s_waitcnt lgkmcnt(8)
    ds_read_b64_tr_b16 v[170:171], v186 offset:9216
    v_xor_b32 v191, 32, v186
    v_mfma_f32_16x16x32_bf16 v[244:247], v[172:175], v[32:35], v[244:247]
    ds_read_b64_tr_b16 v[168:169], v186 offset:8192
    v_mfma_f32_16x16x32_bf16 v[252:255], v[172:175], v[36:39], v[252:255]
    s_waitcnt lgkmcnt(8)
    ds_read_b64_tr_b16 v[174:175], v191 offset:9216
    v_add_u32 v186, s55, v186
    v_mfma_f32_16x16x32_bf16 v[192:195], v[176:179], v[40:43], v[192:195]
    ds_read_b64_tr_b16 v[172:173], v191 offset:8192
    v_mfma_f32_16x16x32_bf16 v[200:203], v[176:179], v[44:47], v[200:203]
    s_waitcnt lgkmcnt(8)
    ds_read_b64_tr_b16 v[178:179], v187 offset:9216
    v_xor_b32 v191, 32, v187
    v_mfma_f32_16x16x32_bf16 v[196:199], v[180:183], v[40:43], v[196:199]
    ds_read_b64_tr_b16 v[176:177], v187 offset:8192
    v_mfma_f32_16x16x32_bf16 v[204:207], v[180:183], v[44:47], v[204:207]
    s_waitcnt lgkmcnt(8)
    ds_read_b64_tr_b16 v[182:183], v191 offset:9216
    v_add_u32 v187, s55, v187
    v_mfma_f32_16x16x32_bf16 v[208:211], v[160:163], v[40:43], v[208:211]
    ds_read_b64_tr_b16 v[180:181], v191 offset:8192
    v_mfma_f32_16x16x32_bf16 v[216:219], v[160:163], v[44:47], v[216:219]
    s_waitcnt lgkmcnt(8)
    s_cbranch_scc0 LG_q_xa2
LG_q_xb2:
    ds_read_b64_tr_b16 v[162:163], v184 offset:1024
    v_xor_b32 v191, 32, v184
    v_mfma_f32_16x16x32_bf16 v[212:215], v[164:167], v[40:43], v[212:215]
    ds_read_b64_tr_b16 v[160:161], v184 offset:0
    v_mfma_f32_16x16x32_bf16 v[220:223], v[164:167], v[44:47], v[220:223]
    s_waitcnt lgkmcnt(8)
    ds_read_b64_tr_b16 v[166:167], v191 offset:1024
    v_mfma_f32_16x16x32_bf16 v[224:227], v[168:171], v[40:43], v[224:227]
    s_getreg_b32 s47, hwreg(HW_REG_IB_STS, 0, 4)
    ds_read_b64_tr_b16 v[164:165], v191 offset:0
    v_mfma_f32_16x16x32_bf16 v[232:235], v[168:171], v[44:47], v[232:235]
    s_waitcnt lgkmcnt(8)
    ds_read_b64_tr_b16 v[170:171], v185 offset:1024
    v_xor_b32 v191, 32, v185
    v_mfma_f32_16x16x32_bf16 v[228:231], v[172:175], v[40:43], v[228:231]
    s_or_b32 s47, s47, s36
    ds_read_b64_tr_b16 v[168:169], v185 offset:0
    v_mfma_f32_16x16x32_bf16 v[236:239], v[172:175], v[44:47], v[236:239]
    s_waitcnt lgkmcnt(8)
    ds_read_b64_tr_b16 v[174:175], v191 offset:1024
    v_mfma_f32_16x16x32_bf16 v[240:243], v[176:179], v[40:43], v[240:243]
    s_cbranch_scc0 LG_q_da2
LG_q_db2:
    ds_read_b64_tr_b16 v[172:173], v191 offset:0
    v_mfma_f32_16x16x32_bf16 v[248:251], v[176:179], v[44:47], v[248:251]
    s_waitcnt lgkmcnt(8)
    ds_read_b64_tr_b16 v[178:179], v186 offset:1024
    v_xor_b32 v191, 32, v186
    v_mfma_f32_16x16x32_bf16 v[244:247], v[180:183], v[40:43], v[244:247]
    ds_read_b64_tr_b16 v[176:177], v186 offset:0
    v_mfma_f32_16x16x32_bf16 v[252:255], v[180:183], v[44:47], v[252:255]
    s_waitcnt lgkmcnt(8)
    ds_read_b64_tr_b16 v[182:183], v191 offset:1024
    v_mfma_f32_16x16x32_bf16 v[192:195], v[160:163], v[48:51], v[192:195]
    s_cmp_eq_u32 s99, 1
    ds_read_b64_tr_b16 v[180:181], v191 offset:0
    v_mfma_f32_16x16x32_bf16 v[200:203], v[160:163], v[52:55], v[200:203]
    s_waitcnt lgkmcnt(8)
    ds_read_b64_tr_b16 v[162:163], v187 offset:1024
    v_xor_b32 v191, 32, v187
    v_mfma_f32_16x16x32_bf16 v[196:199], v[164:167], v[48:51], v[196:199]
    s_mov_b32 s55, 32768
    ds_read_b64_tr_b16 v[160:161], v187 offset:0
    v_mfma_f32_16x16x32_bf16 v[204:207], v[164:167], v[52:55], v[204:207]
    s_waitcnt lgkmcnt(8)
    ds_read_b64_tr_b16 v[166:167], v191 offset:1024
    v_mfma_f32_16x16x32_bf16 v[208:211], v[168:171], v[48:51], v[208:211]
    s_cmov_b32 s55, 16384
    ds_read_b64_tr_b16 v[164:165], v191 offset:0
    v_mfma_f32_16x16x32_bf16 v[216:219], v[168:171], v[52:55], v[216:219]
    s_waitcnt lgkmcnt(8)
    ds_read_b64_tr_b16 v[170:171], v184 offset:9216
    v_xor_b32 v191, 32, v184
    v_mfma_f32_16x16x32_bf16 v[212:215], v[172:175], v[48:51], v[212:215]
    ds_read_b64_tr_b16 v[168:169], v184 offset:8192
    v_mfma_f32_16x16x32_bf16 v[220:223], v[172:175], v[52:55], v[220:223]
    s_waitcnt lgkmcnt(8)
    ds_read_b64_tr_b16 v[174:175], v191 offset:9216
    v_add_u32 v184, s55, v184
    v_mfma_f32_16x16x32_bf16 v[224:227], v[176:179], v[48:51], v[224:227]
    ds_read_b64_tr_b16 v[172:173], v191 offset:8192
    v_mfma_f32_16x16x32_bf16 v[232:235], v[176:179], v[52:55], v[232:235]
    s_waitcnt lgkmcnt(8)
    ds_read_b64_tr_b16 v[178:179], v185 offset:9216
    v_xor_b32 v191, 32, v185
    v_mfma_f32_16x16x32_bf16 v[228:231], v[180:183], v[48:51], v[228:231]
    ds_read_b64_tr_b16 v[176:177], v185 offset:8192
    v_mfma_f32_16x16x32_bf16 v[236:239], v[180:183], v[52:55], v[236:239]
    s_waitcnt lgkmcnt(8)
    ds_read_b64_tr_b16 v[182:183], v191 offset:9216
    v_add_u32 v185, s55, v185
    v_mfma_f32_16x16x32_bf16 v[240:243], v[160:163], v[48:51], v[240:243]
    ds_read_b64_tr_b16 v[180:181], v191 offset:8192
    v_mfma_f32_16x16x32_bf16 v[248:251], v[160:163], v[52:55], v[248:251]
    s_waitcnt lgkmcnt(8)
    ds_read_b64_tr_b16 v[162:163], v186 offset:9216
    v_xor_b32 v191, 32, v186
    v_mfma_f32_16x16x32_bf16 v[244:247], v[164:167], v[48:51], v[244:247]
    ds_read_b64_tr_b16 v[160:161], v186 offset:8192
    v_mfma_f32_16x16x32_bf16 v[252:255], v[164:167], v[52:55], v[252:255]
    s_waitcnt lgkmcnt(8)
    ds_read_b64_tr_b16 v[166:167], v191 offset:9216
    v_add_u32 v186, s55, v186
    v_mfma_f32_16x16x32_bf16 v[192:195], v[168:171], v[56:59], v[192:195]
    ds_read_b64_tr_b16 v[164:165], v191 offset:8192
    v_mfma_f32_16x16x32_bf16 v[200:203], v[168:171], v[60:63], v[200:203]
    s_waitcnt lgkmcnt(8)
    ds_read_b64_tr_b16 v[170:171], v187 offset:9216
    v_xor_b32 v191, 32, v187
    v_mfma_f32_16x16x32_bf16 v[196:199], v[172:175], v[56:59], v[196:199]
    ds_read_b64_tr_b16 v[168:169], v187 offset:8192
    v_mfma_f32_16x16x32_bf16 v[204:207], v[172:175], v[60:63], v[204:207]
    s_waitcnt lgkmcnt(8)
    ds_read_b64_tr_b16 v[174:175], v191 offset:9216
    v_add_u32 v187, s55, v187
    v_mfma_f32_16x16x32_bf16 v[208:211], v[176:179], v[56:59], v[208:211]
    ds_read_b64_tr_b16 v[172:173], v191 offset:8192
    v_mfma_f32_16x16x32_bf16 v[216:219], v[176:179], v[60:63], v[216:219]
    s_waitcnt lgkmcnt(8)
    s_cbranch_scc0 LG_q_xa3
LG_q_xb3:
    ds_read_b64_tr_b16 v[178:179], v184 offset:1024
    v_xor_b32 v191, 32, v184
    v_mfma_f32_16x16x32_bf16 v[212:215], v[180:183], v[56:59], v[212:215]
    ds_read_b64_tr_b16 v[176:177], v184 offset:0
    v_mfma_f32_16x16x32_bf16 v[220:223], v[180:183], v[60:63], v[220:223]
    s_waitcnt lgkmcnt(8)
    ds_read_b64_tr_b16 v[182:183], v191 offset:1024
    v_mfma_f32_16x16x32_bf16 v[224:227], v[160:163], v[56:59], v[224:227]
    s_getreg_b32 s47, hwreg(HW_REG_IB_STS, 0, 4)
    ds_read_b64_tr_b16 v[180:181], v191 offset:0
    v_mfma_f32_16x16x32_bf16 v[232:235], v[160:163], v[60:63], v[232:235]
    s_waitcnt lgkmcnt(8)
    ds_read_b64_tr_b16 v[162:163], v185 offset:1024
    v_xor_b32 v191, 32, v185
    v_mfma_f32_16x16x32_bf16 v[228:231], v[164:167], v[56:59], v[228:231]
    s_or_b32 s47, s47, s36
    ds_read_b64_tr_b16 v[160:161], v185 offset:0
    v_mfma_f32_16x16x32_bf16 v[236:239], v[164:167], v[60:63], v[236:239]
    s_waitcnt lgkmcnt(8)
    ds_read_b64_tr_b16 v[166:167], v191 offset:1024
    v_mfma_f32_16x16x32_bf16 v[240:243], v[168:171], v[56:59], v[240:243]
    s_cbranch_scc0 LG_q_da3
LG_q_db3:
    ds_read_b64_tr_b16 v[164:165], v191 offset:0
    v_mfma_f32_16x16x32_bf16 v[248:251], v[168:171], v[60:63], v[248:251]
    s_waitcnt lgkmcnt(8)
    ds_read_b64_tr_b16 v[170:171], v186 offset:1024
    v_xor_b32 v191, 32, v186
    v_mfma_f32_16x16x32_bf16 v[244:247], v[172:175], v[56:59], v[244:247]
    ds_read_b64_tr_b16 v[168:169], v186 offset:0
    v_mfma_f32_16x16x32_bf16 v[252:255], v[172:175], v[60:63], v[252:255]
    s_waitcnt lgkmcnt(8)
    ds_read_b64_tr_b16 v[174:175], v191 offset:1024
    v_mfma_f32_16x16x32_bf16 v[192:195], v[176:179], v[64:67], v[192:195]
    s_cmp_eq_u32 s99, 1
    ds_read_b64_tr_b16 v[172:173], v191 offset:0
    v_mfma_f32_16x16x32_bf16 v[200:203], v[176:179], v[68:71], v[200:203]
    s_waitcnt lgkmcnt(8)
    ds_read_b64_tr_b16 v[178:179], v187 offset:1024
    v_xor_b32 v191, 32, v187
    v_mfma_f32_16x16x32_bf16 v[196:199], v[180:183], v[64:67], v[196:199]
    s_mov_b32 s55, 65536
    ds_read_b64_tr_b16 v[176:177], v187 offset:0
    v_mfma_f32_16x16x32_bf16 v[204:207], v[180:183], v[68:71], v[204:207]
    s_waitcnt lgkmcnt(8)
    ds_read_b64_tr_b16 v[182:183], v191 offset:1024
    v_mfma_f32_16x16x32_bf16 v[208:211], v[160:163], v[64:67], v[208:211]
    s_cmov_b32 s55, 4294868992
    ds_read_b64_tr_b16 v[180:181], v191 offset:0
    v_mfma_f32_16x16x32_bf16 v[216:219], v[160:163], v[68:71], v[216:219]
    s_waitcnt lgkmcnt(8)
    ds_read_b64_tr_b16 v[162:163], v184 offset:9216
    v_xor_b32 v191, 32, v184
    v_mfma_f32_16x16x32_bf16 v[212:215], v[164:167], v[64:67], v[212:215]
    ds_read_b64_tr_b16 v[160:161], v184 offset:8192
    v_mfma_f32_16x16x32_bf16 v[220:223], v[164:167], v[68:71], v[220:223]
    s_waitcnt lgkmcnt(8)
    ds_read_b64_tr_b16 v[166:167], v191 offset:9216
    v_add_u32 v184, s55, v184
    v_mfma_f32_16x16x32_bf16 v[224:227], v[168:171], v[64:67], v[224:227]
    ds_read_b64_tr_b16 v[164:165], v191 offset:8192
    v_mfma_f32_16x16x32_bf16 v[232:235], v[168:171], v[68:71], v[232:235]
    s_waitcnt lgkmcnt(8)
    ds_read_b64_tr_b16 v[170:171], v185 offset:9216
    v_xor_b32 v191, 32, v185
    v_mfma_f32_16x16x32_bf16 v[228:231], v[172:175], v[64:67], v[228:231]
    ds_read_b64_tr_b16 v[168:169], v185 offset:8192
    v_mfma_f32_16x16x32_bf16 v[236:239], v[172:175], v[68:71], v[236:239]
    s_waitcnt lgkmcnt(8)
    ds_read_b64_tr_b16 v[174:175], v191 offset:9216
    v_add_u32 v185, s55, v185
    v_mfma_f32_16x16x32_bf16 v[240:243], v[176:179], v[64:67], v[240:243]
    ds_read_b64_tr_b16 v[172:173], v191 offset:8192
    v_mfma_f32_16x16x32_bf16 v[248:251], v[176:179], v[68:71], v[248:251]
    s_waitcnt lgkmcnt(8)
    ds_read_b64_tr_b16 v[178:179], v186 offset:9216
    v_xor_b32 v191, 32, v186
    v_mfma_f32_16x16x32_bf16 v[244:247], v[180:183], v[64:67], v[244:247]
    ds_read_b64_tr_b16 v[176:177], v186 offset:8192
    v_mfma_f32_16x16x32_bf16 v[252:255], v[180:183], v[68:71], v[252:255]
    s_waitcnt lgkmcnt(8)
    ds_read_b64_tr_b16 v[182:183], v191 offset:9216
    v_add_u32 v186, s55, v186
    v_mfma_f32_16x16x32_bf16 v[192:195], v[160:163], v[72:75], v[192:195]
    ds_read_b64_tr_b16 v[180:181], v191 offset:8192
    v_mfma_f32_16x16x32_bf16 v[200:203], v[160:163], v[76:79], v[200:203]
    s_waitcnt lgkmcnt(8)
    ds_read_b64_tr_b16 v[162:163], v187 offset:9216
    v_xor_b32 v191, 32, v187
    v_mfma_f32_16x16x32_bf16 v[196:199], v[164:167], v[72:75], v[196:199]
    ds_read_b64_tr_b16 v[160:161], v187 offset:8192
    v_mfma_f32_16x16x32_bf16 v[204:207], v[164:167], v[76:79], v[204:207]
    s_waitcnt lgkmcnt(8)
    ds_read_b64_tr_b16 v[166:167], v191 offset:9216
    v_add_u32 v187, s55, v187
    v_mfma_f32_16x16x32_bf16 v[208:211], v[168:171], v[72:75], v[208:211]
    ds_read_b64_tr_b16 v[164:165], v191 offset:8192
    v_mfma_f32_16x16x32_bf16 v[216:219], v[168:171], v[76:79], v[216:219]
    s_waitcnt lgkmcnt(8)
    s_cbranch_scc0 LG_q_xa4
LG_q_xb4:
    ds_read_b64_tr_b16 v[170:171], v184 offset:1024
    v_xor_b32 v191, 32, v184
    v_mfma_f32_16x16x32_bf16 v[212:215], v[172:175], v[72:75], v[212:215]
    ds_read_b64_tr_b16 v[168:169], v184 offset:0
    v_mfma_f32_16x16x32_bf16 v[220:223], v[172:175], v[76:79], v[220:223]
    s_waitcnt lgkmcnt(8)
    ds_read_b64_tr_b16 v[174:175], v191 offset:1024
    v_mfma_f32_16x16x32_bf16 v[224:227], v[176:179], v[72:75], v[224:227]
    s_mov_b32 s47, 0
    ds_read_b64_tr_b16 v[172:173], v191 offset:0
    v_mfma_f32_16x16x32_bf16 v[232:235], v[176:179], v[76:79], v[232:235]
    s_waitcnt lgkmcnt(8)
    ds_read_b64_tr_b16 v[178:179], v185 offset:1024
    v_xor_b32 v191, 32, v185
    v_mfma_f32_16x16x32_bf16 v[228:231], v[180:183], v[72:75], v[228:231]
    s_or_b32 s47, s47, s36
    ds_read_b64_tr_b16 v[176:177], v185 offset:0
    v_mfma_f32_16x16x32_bf16 v[236:239], v[180:183], v[76:79], v[236:239]
    s_waitcnt lgkmcnt(8)
    ds_read_b64_tr_b16 v[182:183], v191 offset:1024
    v_mfma_f32_16x16x32_bf16 v[240:243], v[160:163], v[72:75], v[240:243]
    s_cbranch_scc0 LG_q_da4
LG_q_db4:
    ds_read_b64_tr_b16 v[180:181], v191 offset:0
    v_mfma_f32_16x16x32_bf16 v[248:251], v[160:163], v[76:79], v[248:251]
    s_waitcnt lgkmcnt(8)
    ds_read_b64_tr_b16 v[162:163], v186 offset:1024
    v_xor_b32 v191, 32, v186
    v_mfma_f32_16x16x32_bf16 v[244:247], v[164:167], v[72:75], v[244:247]
    ds_read_b64_tr_b16 v[160:161], v186 offset:0
    v_mfma_f32_16x16x32_bf16 v[252:255], v[164:167], v[76:79], v[252:255]
    s_waitcnt lgkmcnt(8)
    ds_read_b64_tr_b16 v[166:167], v191 offset:1024
    v_mfma_f32_16x16x32_bf16 v[192:195], v[168:171], v[80:83], v[192:195]
    s_cmp_eq_u32 s99, 1
    ds_read_b64_tr_b16 v[164:165], v191 offset:0
    v_mfma_f32_16x16x32_bf16 v[200:203], v[168:171], v[84:87], v[200:203]
    s_waitcnt lgkmcnt(8)
    ds_read_b64_tr_b16 v[170:171], v187 offset:1024
    v_xor_b32 v191, 32, v187
    v_mfma_f32_16x16x32_bf16 v[196:199], v[172:175], v[80:83], v[196:199]
    s_mov_b32 s55, 4294918144
    ds_read_b64_tr_b16 v[168:169], v187 offset:0
    v_mfma_f32_16x16x32_bf16 v[204:207], v[172:175], v[84:87], v[204:207]
    s_waitcnt lgkmcnt(8)
    ds_read_b64_tr_b16 v[174:175], v191 offset:1024
    v_mfma_f32_16x16x32_bf16 v[208:211], v[176:179], v[80:83], v[208:211]
    s_cmov_b32 s55, 16384
    ds_read_b64_tr_b16 v[172:173], v191 offset:0
    v_mfma_f32_16x16x32_bf16 v[216:219], v[176:179], v[84:87], v[216:219]
    s_waitcnt lgkmcnt(8)
    ds_read_b64_tr_b16 v[178:179], v184 offset:9216
    v_xor_b32 v191, 32, v184
    v_mfma_f32_16x16x32_bf16 v[212:215], v[180:183], v[80:83], v[212:215]
    ds_read_b64_tr_b16 v[176:177], v184 offset:8192
    v_mfma_f32_16x16x32_bf16 v[220:223], v[180:183], v[84:87], v[220:223]
    s_waitcnt lgkmcnt(8)
    ds_read_b64_tr_b16 v[182:183], v191 offset:9216
    v_add_u32 v184, s55, v184
    v_mfma_f32_16x16x32_bf16 v[224:227], v[160:163], v[80:83], v[224:227]
    ds_read_b64_tr_b16 v[180:181], v191 offset:8192
    v_mfma_f32_16x16x32_bf16 v[232:235], v[160:163], v[84:87], v[232:235]
    s_waitcnt lgkmcnt(8)
    ds_read_b64_tr_b16 v[162:163], v185 offset:9216
    v_xor_b32 v191, 32, v185
    v_mfma_f32_16x16x32_bf16 v[228:231], v[164:167], v[80:83], v[228:231]
    ds_read_b64_tr_b16 v[160:161], v185 offset:8192
    v_mfma_f32_16x16x32_bf16 v[236:239], v[164:167], v[84:87], v[236:239]
    s_waitcnt lgkmcnt(8)
    ds_read_b64_tr_b16 v[166:167], v191 offset:9216
    v_add_u32 v185, s55, v185
    v_mfma_f32_16x16x32_bf16 v[240:243], v[168:171], v[80:83], v[240:243]
    ds_read_b64_tr_b16 v[164:165], v191 offset:8192
    v_mfma_f32_16x16x32_bf16 v[248:251], v[168:171], v[84:87], v[248:251]
    s_waitcnt lgkmcnt(8)
    ds_read_b64_tr_b16 v[170:171], v186 offset:9216
    v_xor_b32 v191, 32, v186
    v_mfma_f32_16x16x32_bf16 v[244:247], v[172:175], v[80:83], v[244:247]
    ds_read_b64_tr_b16 v[168:169], v186 offset:8192
    v_mfma_f32_16x16x32_bf16 v[252:255], v[172:175], v[84:87], v[252:255]
    s_waitcnt lgkmcnt(8)
    ds_read_b64_tr_b16 v[174:175], v191 offset:9216
    v_add_u32 v186, s55, v186
    v_mfma_f32_16x16x32_bf16 v[192:195], v[176:179], v[88:91], v[192:195]
    ds_read_b64_tr_b16 v[172:173], v191 offset:8192
    v_mfma_f32_16x16x32_bf16 v[200:203], v[176:179], v[92:95], v[200:203]
    s_waitcnt lgkmcnt(8)
    ds_read_b64_tr_b16 v[178:179], v187 offset:9216
    v_xor_b32 v191, 32, v187
    v_mfma_f32_16x16x32_bf16 v[196:199], v[180:183], v[88:91], v[196:199]
    ds_read_b64_tr_b16 v[176:177], v187 offset:8192
    v_mfma_f32_16x16x32_bf16 v[204:207], v[180:183], v[92:95], v[204:207]
    s_waitcnt lgkmcnt(8)
    ds_read_b64_tr_b16 v[182:183], v191 offset:9216
    v_add_u32 v187, s55, v187
    v_mfma_f32_16x16x32_bf16 v[208:211], v[160:163], v[88:91], v[208:211]
    ds_read_b64_tr_b16 v[180:181], v191 offset:8192
    v_mfma_f32_16x16x32_bf16 v[216:219], v[160:163], v[92:95], v[216:219]
    s_waitcnt lgkmcnt(8)
    s_barrier
    s_cbranch_scc0 LG_q_xa5
LG_q_xb5:
    ds_read_b64_tr_b16 v[162:163], v184 offset:1024
    v_xor_b32 v191, 32, v184
    v_mfma_f32_16x16x32_bf16 v[212:215], v[164:167], v[88:91], v[212:215]
    ds_read_b64_tr_b16 v[160:161], v184 offset:0
    v_mfma_f32_16x16x32_bf16 v[220:223], v[164:167], v[92:95], v[220:223]
    s_waitcnt lgkmcnt(8)
    ds_read_b64_tr_b16 v[166:167], v191 offset:1024
    v_mfma_f32_16x16x32_bf16 v[224:227], v[168:171], v[88:91], v[224:227]
    ds_read_b64_tr_b16 v[164:165], v191 offset:0
    v_mfma_f32_16x16x32_bf16 v[232:235], v[168:171], v[92:95], v[232:235]
    s_waitcnt lgkmcnt(8)
    ds_read_b64_tr_b16 v[170:171], v185 offset:1024
    v_xor_b32 v191, 32, v185
    v_mfma_f32_16x16x32_bf16 v[228:231], v[172:175], v[88:91], v[228:231]
    ds_read_b64_tr_b16 v[168:169], v185 offset:0
    v_mfma_f32_16x16x32_bf16 v[236:239], v[172:175], v[92:95], v[236:239]
    s_waitcnt lgkmcnt(8)
    ds_read_b64_tr_b16 v[174:175], v191 offset:1024
    v_mfma_f32_16x16x32_bf16 v[240:243], v[176:179], v[88:91], v[240:243]
    ds_read_b64_tr_b16 v[172:173], v191 offset:0
    v_mfma_f32_16x16x32_bf16 v[248:251], v[176:179], v[92:95], v[248:251]
    s_waitcnt lgkmcnt(8)
    ds_read_b64_tr_b16 v[178:179], v186 offset:1024
    v_xor_b32 v191, 32, v186
    v_mfma_f32_16x16x32_bf16 v[244:247], v[180:183], v[88:91], v[244:247]
    ds_read_b64_tr_b16 v[176:177], v186 offset:0
    v_mfma_f32_16x16x32_bf16 v[252:255], v[180:183], v[92:95], v[252:255]
    s_waitcnt lgkmcnt(8)
    ds_read_b64_tr_b16 v[182:183], v191 offset:1024
    v_mfma_f32_16x16x32_bf16 v[192:195], v[160:163], v[96:99], v[192:195]
    s_cmp_eq_u32 s99, 1
    ds_read_b64_tr_b16 v[180:181], v191 offset:0
    v_mfma_f32_16x16x32_bf16 v[200:203], v[160:163], v[100:103], v[200:203]
    s_waitcnt lgkmcnt(8)
    ds_read_b64_tr_b16 v[162:163], v187 offset:1024
    v_xor_b32 v191, 32, v187
    v_mfma_f32_16x16x32_bf16 v[196:199], v[164:167], v[96:99], v[196:199]
    s_mov_b32 s55, 4294885376
    ds_read_b64_tr_b16 v[160:161], v187 offset:0
    v_mfma_f32_16x16x32_bf16 v[204:207], v[164:167], v[100:103], v[204:207]
    s_waitcnt lgkmcnt(8)
    ds_read_b64_tr_b16 v[166:167], v191 offset:1024
    v_mfma_f32_16x16x32_bf16 v[208:211], v[168:171], v[96:99], v[208:211]
    s_cmov_b32 s55, 16384
    ds_read_b64_tr_b16 v[164:165], v191 offset:0
    v_mfma_f32_16x16x32_bf16 v[216:219], v[168:171], v[100:103], v[216:219]
    s_waitcnt lgkmcnt(8)
    ds_read_b64_tr_b16 v[170:171], v184 offset:9216
    v_xor_b32 v191, 32, v184
    v_mfma_f32_16x16x32_bf16 v[212:215], v[172:175], v[96:99], v[212:215]
    ds_read_b64_tr_b16 v[168:169], v184 offset:8192
    v_mfma_f32_16x16x32_bf16 v[220:223], v[172:175], v[100:103], v[220:223]
    s_waitcnt lgkmcnt(8)
    ds_read_b64_tr_b16 v[174:175], v191 offset:9216
    v_add_u32 v184, s55, v184
    v_mfma_f32_16x16x32_bf16 v[224:227], v[176:179], v[96:99], v[224:227]
    ds_read_b64_tr_b16 v[172:173], v191 offset:8192
    v_mfma_f32_16x16x32_bf16 v[232:235], v[176:179], v[100:103], v[232:235]
    s_waitcnt lgkmcnt(8)
    ds_read_b64_tr_b16 v[178:179], v185 offset:9216
    v_xor_b32 v191, 32, v185
    v_mfma_f32_16x16x32_bf16 v[228:231], v[180:183], v[96:99], v[228:231]
    ds_read_b64_tr_b16 v[176:177], v185 offset:8192
    v_mfma_f32_16x16x32_bf16 v[236:239], v[180:183], v[100:103], v[236:239]
    s_waitcnt lgkmcnt(8)
    ds_read_b64_tr_b16 v[182:183], v191 offset:9216
    v_add_u32 v185, s55, v185
    v_mfma_f32_16x16x32_bf16 v[240:243], v[160:163], v[96:99], v[240:243]
    ds_read_b64_tr_b16 v[180:181], v191 offset:8192
    v_mfma_f32_16x16x32_bf16 v[248:251], v[160:163], v[100:103], v[248:251]
    s_waitcnt lgkmcnt(8)
    ds_read_b64_tr_b16 v[162:163], v186 offset:9216
    v_xor_b32 v191, 32, v186
    v_mfma_f32_16x16x32_bf16 v[244:247], v[164:167], v[96:99], v[244:247]
    ds_read_b64_tr_b16 v[160:161], v186 offset:8192
    v_mfma_f32_16x16x32_bf16 v[252:255], v[164:167], v[100:103], v[252:255]
    s_waitcnt lgkmcnt(8)
    ds_read_b64_tr_b16 v[166:167], v191 offset:9216
    v_add_u32 v186, s55, v186
    v_mfma_f32_16x16x32_bf16 v[192:195], v[168:171], v[104:107], v[192:195]
    ds_read_b64_tr_b16 v[164:165], v191 offset:8192
    v_mfma_f32_16x16x32_bf16 v[200:203], v[168:171], v[108:111], v[200:203]
    s_waitcnt lgkmcnt(8)
    ds_read_b64_tr_b16 v[170:171], v187 offset:9216
    v_xor_b32 v191, 32, v187
    v_mfma_f32_16x16x32_bf16 v[196:199], v[172:175], v[104:107], v[196:199]
    ds_read_b64_tr_b16 v[168:169], v187 offset:8192
    v_mfma_f32_16x16x32_bf16 v[204:207], v[172:175], v[108:111], v[204:207]
    s_waitcnt lgkmcnt(8)
    ds_read_b64_tr_b16 v[174:175], v191 offset:9216
    v_add_u32 v187, s55, v187
    v_mfma_f32_16x16x32_bf16 v[208:211], v[176:179], v[104:107], v[208:211]
    ds_read_b64_tr_b16 v[172:173], v191 offset:8192
    v_mfma_f32_16x16x32_bf16 v[216:219], v[176:179], v[108:111], v[216:219]
    s_waitcnt lgkmcnt(8)
    s_cbranch_scc0 LG_q_xa6
LG_q_xb6:
    ds_read_b64_tr_b16 v[178:179], v184 offset:1024
    v_xor_b32 v191, 32, v184
    v_mfma_f32_16x16x32_bf16 v[212:215], v[180:183], v[104:107], v[212:215]
    ds_read_b64_tr_b16 v[176:177], v184 offset:0
    v_mfma_f32_16x16x32_bf16 v[220:223], v[180:183], v[108:111], v[220:223]
    s_waitcnt lgkmcnt(8)
    ds_read_b64_tr_b16 v[182:183], v191 offset:1024
    v_mfma_f32_16x16x32_bf16 v[224:227], v[160:163], v[104:107], v[224:227]
    ds_read_b64_tr_b16 v[180:181], v191 offset:0
    v_mfma_f32_16x16x32_bf16 v[232:235], v[160:163], v[108:111], v[232:235]
    s_waitcnt lgkmcnt(8)
    ds_read_b64_tr_b16 v[162:163], v185 offset:1024
    v_xor_b32 v191, 32, v185
    v_mfma_f32_16x16x32_bf16 v[228:231], v[164:167], v[104:107], v[228:231]
    ds_read_b64_tr_b16 v[160:161], v185 offset:0
    v_mfma_f32_16x16x32_bf16 v[236:239], v[164:167], v[108:111], v[236:239]
    s_waitcnt lgkmcnt(8)
    ds_read_b64_tr_b16 v[166:167], v191 offset:1024
    v_mfma_f32_16x16x32_bf16 v[240:243], v[168:171], v[104:107], v[240:243]
    ds_read_b64_tr_b16 v[164:165], v191 offset:0
    v_mfma_f32_16x16x32_bf16 v[248:251], v[168:171], v[108:111], v[248:251]
    s_waitcnt lgkmcnt(8)
    ds_read_b64_tr_b16 v[170:171], v186 offset:1024
    v_xor_b32 v191, 32, v186
    v_mfma_f32_16x16x32_bf16 v[244:247], v[172:175], v[104:107], v[244:247]
    ds_read_b64_tr_b16 v[168:169], v186 offset:0
    v_mfma_f32_16x16x32_bf16 v[252:255], v[172:175], v[108:111], v[252:255]
    s_waitcnt lgkmcnt(8)
    ds_read_b64_tr_b16 v[174:175], v191 offset:1024
    v_mfma_f32_16x16x32_bf16 v[192:195], v[176:179], v[112:115], v[192:195]
    s_cmp_eq_u32 s99, 1
    ds_read_b64_tr_b16 v[172:173], v191 offset:0
    v_mfma_f32_16x16x32_bf16 v[200:203], v[176:179], v[116:119], v[200:203]
    s_waitcnt lgkmcnt(8)
    ds_read_b64_tr_b16 v[178:179], v187 offset:1024
    v_xor_b32 v191, 32, v187
    v_mfma_f32_16x16x32_bf16 v[196:199], v[180:183], v[112:115], v[196:199]
    s_mov_b32 s55, 32768
    ds_read_b64_tr_b16 v[176:177], v187 offset:0
    v_mfma_f32_16x16x32_bf16 v[204:207], v[180:183], v[116:119], v[204:207]
    s_waitcnt lgkmcnt(8)
    ds_read_b64_tr_b16 v[182:183], v191 offset:1024
    v_mfma_f32_16x16x32_bf16 v[208:211], v[160:163], v[112:115], v[208:211]
    s_cmov_b32 s55, 16384
    ds_read_b64_tr_b16 v[180:181], v191 offset:0
    v_mfma_f32_16x16x32_bf16 v[216:219], v[160:163], v[116:119], v[216:219]
    s_waitcnt lgkmcnt(8)
    ds_read_b64_tr_b16 v[162:163], v184 offset:9216
    v_xor_b32 v191, 32, v184
    v_mfma_f32_16x16x32_bf16 v[212:215], v[164:167], v[112:115], v[212:215]
    ds_read_b64_tr_b16 v[160:161], v184 offset:8192
    v_mfma_f32_16x16x32_bf16 v[220:223], v[164:167], v[116:119], v[220:223]
    s_waitcnt lgkmcnt(8)
    ds_read_b64_tr_b16 v[166:167], v191 offset:9216
    v_add_u32 v184, s55, v184
    v_mfma_f32_16x16x32_bf16 v[224:227], v[168:171], v[112:115], v[224:227]
    ds_read_b64_tr_b16 v[164:165], v191 offset:8192
    v_mfma_f32_16x16x32_bf16 v[232:235], v[168:171], v[116:119], v[232:235]
    s_waitcnt lgkmcnt(8)
    ds_read_b64_tr_b16 v[170:171], v185 offset:9216
    v_xor_b32 v191, 32, v185
    v_mfma_f32_16x16x32_bf16 v[228:231], v[172:175], v[112:115], v[228:231]
    ds_read_b64_tr_b16 v[168:169], v185 offset:8192
    v_mfma_f32_16x16x32_bf16 v[236:239], v[172:175], v[116:119], v[236:239]
    s_waitcnt lgkmcnt(8)
    ds_read_b64_tr_b16 v[174:175], v191 offset:9216
    v_add_u32 v185, s55, v185
    v_mfma_f32_16x16x32_bf16 v[240:243], v[176:179], v[112:115], v[240:243]
    ds_read_b64_tr_b16 v[172:173], v191 offset:8192
    v_mfma_f32_16x16x32_bf16 v[248:251], v[176:179], v[116:119], v[248:251]
    s_waitcnt lgkmcnt(8)
    ds_read_b64_tr_b16 v[178:179], v186 offset:9216
    v_xor_b32 v191, 32, v186
    v_mfma_f32_16x16x32_bf16 v[244:247], v[180:183], v[112:115], v[244:247]
    ds_read_b64_tr_b16 v[176:177], v186 offset:8192
    v_mfma_f32_16x16x32_bf16 v[252:255], v[180:183], v[116:119], v[252:255]
    s_waitcnt lgkmcnt(8)
    ds_read_b64_tr_b16 v[182:183], v191 offset:9216
    v_add_u32 v186, s55, v186
    v_mfma_f32_16x16x32_bf16 v[192:195], v[160:163], v[120:123], v[192:195]
    ds_read_b64_tr_b16 v[180:181], v191 offset:8192
    v_mfma_f32_16x16x32_bf16 v[200:203], v[160:163], v[124:127], v[200:203]
    s_waitcnt lgkmcnt(8)
    ds_read_b64_tr_b16 v[162:163], v187 offset:9216
    v_xor_b32 v191, 32, v187
    v_mfma_f32_16x16x32_bf16 v[196:199], v[164:167], v[120:123], v[196:199]
    ds_read_b64_tr_b16 v[160:161], v187 offset:8192
    v_mfma_f32_16x16x32_bf16 v[204:207], v[164:167], v[124:127], v[204:207]
    s_waitcnt lgkmcnt(8)
    ds_read_b64_tr_b16 v[166:167], v191 offset:9216
    v_add_u32 v187, s55, v187
    v_mfma_f32_16x16x32_bf16 v[208:211], v[168:171], v[120:123], v[208:211]
    ds_read_b64_tr_b16 v[164:165], v191 offset:8192
    v_mfma_f32_16x16x32_bf16 v[216:219], v[168:171], v[124:127], v[216:219]
    s_waitcnt lgkmcnt(8)
    s_cbranch_scc0 LG_q_xa7
LG_q_xb7:
    ds_read_b64_tr_b16 v[170:171], v184 offset:1024
    v_xor_b32 v191, 32, v184
    v_mfma_f32_16x16x32_bf16 v[212:215], v[172:175], v[120:123], v[212:215]
    ds_read_b64_tr_b16 v[168:169], v184 offset:0
    v_mfma_f32_16x16x32_bf16 v[220:223], v[172:175], v[124:127], v[220:223]
    s_waitcnt lgkmcnt(8)
    ds_read_b64_tr_b16 v[174:175], v191 offset:1024
    v_mfma_f32_16x16x32_bf16 v[224:227], v[176:179], v[120:123], v[224:227]
    ds_read_b64_tr_b16 v[172:173], v191 offset:0
    v_mfma_f32_16x16x32_bf16 v[232:235], v[176:179], v[124:127], v[232:235]
    s_waitcnt lgkmcnt(8)
    ds_read_b64_tr_b16 v[178:179], v185 offset:1024
    v_xor_b32 v191, 32, v185
    v_mfma_f32_16x16x32_bf16 v[228:231], v[180:183], v[120:123], v[228:231]
    ds_read_b64_tr_b16 v[176:177], v185 offset:0
    v_mfma_f32_16x16x32_bf16 v[236:239], v[180:183], v[124:127], v[236:239]
    s_waitcnt lgkmcnt(8)
    ds_read_b64_tr_b16 v[182:183], v191 offset:1024
    v_mfma_f32_16x16x32_bf16 v[240:243], v[160:163], v[120:123], v[240:243]
    ds_read_b64_tr_b16 v[180:181], v191 offset:0
    v_mfma_f32_16x16x32_bf16 v[248:251], v[160:163], v[124:127], v[248:251]
    s_waitcnt lgkmcnt(8)
    ds_read_b64_tr_b16 v[162:163], v186 offset:1024
    v_xor_b32 v191, 32, v186
    v_mfma_f32_16x16x32_bf16 v[244:247], v[164:167], v[120:123], v[244:247]
    ds_read_b64_tr_b16 v[160:161], v186 offset:0
    v_mfma_f32_16x16x32_bf16 v[252:255], v[164:167], v[124:127], v[252:255]
    s_waitcnt lgkmcnt(8)
    ds_read_b64_tr_b16 v[166:167], v191 offset:1024
    v_mfma_f32_16x16x32_bf16 v[192:195], v[168:171], v[128:131], v[192:195]
    s_cmp_eq_u32 s99, 1
    ds_read_b64_tr_b16 v[164:165], v191 offset:0
    v_mfma_f32_16x16x32_bf16 v[200:203], v[168:171], v[132:135], v[200:203]
    s_waitcnt lgkmcnt(8)
    ds_read_b64_tr_b16 v[170:171], v187 offset:1024
    v_xor_b32 v191, 32, v187
    v_mfma_f32_16x16x32_bf16 v[196:199], v[172:175], v[128:131], v[196:199]
    s_mov_b32 s55, 32768
    ds_read_b64_tr_b16 v[168:169], v187 offset:0
    v_mfma_f32_16x16x32_bf16 v[204:207], v[172:175], v[132:135], v[204:207]
    s_waitcnt lgkmcnt(8)
    ds_read_b64_tr_b16 v[174:175], v191 offset:1024
    v_mfma_f32_16x16x32_bf16 v[208:211], v[176:179], v[128:131], v[208:211]
    s_cmov_b32 s55, 16384
    ds_read_b64_tr_b16 v[172:173], v191 offset:0
    v_mfma_f32_16x16x32_bf16 v[216:219], v[176:179], v[132:135], v[216:219]
    s_waitcnt lgkmcnt(8)
    ds_read_b64_tr_b16 v[178:179], v184 offset:9216
    v_xor_b32 v191, 32, v184
    v_mfma_f32_16x16x32_bf16 v[212:215], v[180:183], v[128:131], v[212:215]
    ds_read_b64_tr_b16 v[176:177], v184 offset:8192
    v_mfma_f32_16x16x32_bf16 v[220:223], v[180:183], v[132:135], v[220:223]
    s_waitcnt lgkmcnt(8)
    ds_read_b64_tr_b16 v[182:183], v191 offset:9216
    v_add_u32 v184, s55, v184
    v_mfma_f32_16x16x32_bf16 v[224:227], v[160:163], v[128:131], v[224:227]
    ds_read_b64_tr_b16 v[180:181], v191 offset:8192
    v_mfma_f32_16x16x32_bf16 v[232:235], v[160:163], v[132:135], v[232:235]
    s_waitcnt lgkmcnt(8)
    ds_read_b64_tr_b16 v[162:163], v185 offset:9216
    v_xor_b32 v191, 32, v185
    v_mfma_f32_16x16x32_bf16 v[228:231], v[164:167], v[128:131], v[228:231]
    ds_read_b64_tr_b16 v[160:161], v185 offset:8192
    v_mfma_f32_16x16x32_bf16 v[236:239], v[164:167], v[132:135], v[236:239]
    s_waitcnt lgkmcnt(8)
    ds_read_b64_tr_b16 v[166:167], v191 offset:9216
    v_add_u32 v185, s55, v185
    v_mfma_f32_16x16x32_bf16 v[240:243], v[168:171], v[128:131], v[240:243]
    ds_read_b64_tr_b16 v[164:165], v191 offset:8192
    v_mfma_f32_16x16x32_bf16 v[248:251], v[168:171], v[132:135], v[248:251]
    s_waitcnt lgkmcnt(8)
    ds_read_b64_tr_b16 v[170:171], v186 offset:9216
    v_xor_b32 v191, 32, v186
    v_mfma_f32_16x16x32_bf16 v[244:247], v[172:175], v[128:131], v[244:247]
    ds_read_b64_tr_b16 v[168:169], v186 offset:8192
    v_mfma_f32_16x16x32_bf16 v[252:255], v[172:175], v[132:135], v[252:255]
    s_waitcnt lgkmcnt(8)
    ds_read_b64_tr_b16 v[174:175], v191 offset:9216
    v_add_u32 v186, s55, v186
    v_mfma_f32_16x16x32_bf16 v[192:195], v[176:179], v[136:139], v[192:195]
    ds_read_b64_tr_b16 v[172:173], v191 offset:8192
    v_mfma_f32_16x16x32_bf16 v[200:203], v[176:179], v[140:143], v[200:203]
    s_waitcnt lgkmcnt(8)
    ds_read_b64_tr_b16 v[178:179], v187 offset:9216
    v_xor_b32 v191, 32, v187
    v_mfma_f32_16x16x32_bf16 v[196:199], v[180:183], v[136:139], v[196:199]
    ds_read_b64_tr_b16 v[176:177], v187 offset:8192
    v_mfma_f32_16x16x32_bf16 v[204:207], v[180:183], v[140:143], v[204:207]
    s_waitcnt lgkmcnt(8)
    ds_read_b64_tr_b16 v[182:183], v191 offset:9216
    v_add_u32 v187, s55, v187
    v_mfma_f32_16x16x32_bf16 v[208:211], v[160:163], v[136:139], v[208:211]
    ds_read_b64_tr_b16 v[180:181], v191 offset:8192
    v_mfma_f32_16x16x32_bf16 v[216:219], v[160:163], v[140:143], v[216:219]
    s_waitcnt lgkmcnt(8)
    s_cbranch_scc0 LG_q_xa8
LG_q_xb8:
    ds_read_b64_tr_b16 v[162:163], v184 offset:1024
    v_mfma_f32_16x16x32_bf16 v[212:215], v[164:167], v[136:139], v[212:215]
    ds_read_b64_tr_b16 v[160:161], v184 offset:0
    v_mfma_f32_16x16x32_bf16 v[220:223], v[164:167], v[140:143], v[220:223]
    s_waitcnt lgkmcnt(8)
    ds_read_b64_tr_b16 v[166:167], v184 offset:9216
    v_xor_b32 v191, 32, v184
    v_mfma_f32_16x16x32_bf16 v[224:227], v[168:171], v[136:139], v[224:227]
    ds_read_b64_tr_b16 v[164:165], v184 offset:8192
    v_mfma_f32_16x16x32_bf16 v[232:235], v[168:171], v[140:143], v[232:235]
    s_waitcnt lgkmcnt(8)
    ds_read_b64_tr_b16 v[170:171], v191 offset:1024
    v_mfma_f32_16x16x32_bf16 v[228:231], v[172:175], v[136:139], v[228:231]
    ds_read_b64_tr_b16 v[168:169], v191 offset:0
    v_mfma_f32_16x16x32_bf16 v[236:239], v[172:175], v[140:143], v[236:239]
    s_waitcnt lgkmcnt(8)
    ds_read_b64_tr_b16 v[174:175], v191 offset:9216
    v_mfma_f32_16x16x32_bf16 v[240:243], v[176:179], v[136:139], v[240:243]
    ds_read_b64_tr_b16 v[172:173], v191 offset:8192
    v_mfma_f32_16x16x32_bf16 v[248:251], v[176:179], v[140:143], v[248:251]
    s_waitcnt lgkmcnt(8)
    ds_read_b64_tr_b16 v[178:179], v185 offset:1024
    v_mfma_f32_16x16x32_bf16 v[244:247], v[180:183], v[136:139], v[244:247]
    ds_read_b64_tr_b16 v[176:177], v185 offset:0
    v_mfma_f32_16x16x32_bf16 v[252:255], v[180:183], v[140:143], v[252:255]
    s_waitcnt lgkmcnt(8)
    ds_read_b64_tr_b16 v[182:183], v185 offset:9216
    v_xor_b32 v191, 32, v185
    v_mfma_f32_16x16x32_bf16 v[192:195], v[160:163], v[144:147], v[192:195]
    s_cmp_eq_u32 s99, 1
    s_setprio 2
    ds_read_b64_tr_b16 v[180:181], v185 offset:8192
    v_mfma_f32_16x16x32_bf16 v[200:203], v[160:163], v[148:151], v[200:203]
    s_waitcnt lgkmcnt(8)
    ds_read_b64_tr_b16 v[162:163], v191 offset:1024
    v_mfma_f32_16x16x32_bf16 v[192:195], v[164:167], v[152:155], v[192:195]
    s_mov_b32 s55, 49152
    ds_read_b64_tr_b16 v[160:161], v191 offset:0
    v_mfma_f32_16x16x32_bf16 v[200:203], v[164:167], v[156:159], v[200:203]
    s_waitcnt lgkmcnt(8)
    ds_read_b64_tr_b16 v[166:167], v191 offset:9216
    v_mfma_f32_16x16x32_bf16 v[196:199], v[168:171], v[144:147], v[196:199]
    ds_read_b64_tr_b16 v[164:165], v191 offset:8192
    v_mfma_f32_16x16x32_bf16 v[204:207], v[168:171], v[148:151], v[204:207]
    s_waitcnt lgkmcnt(8)
    ds_read_b64_tr_b16 v[170:171], v186 offset:1024
    v_mfma_f32_16x16x32_bf16 v[196:199], v[172:175], v[152:155], v[196:199]
    ds_read_b64_tr_b16 v[168:169], v186 offset:0
    v_mfma_f32_16x16x32_bf16 v[204:207], v[172:175], v[156:159], v[204:207]
    s_waitcnt lgkmcnt(8)
    ds_read_b64_tr_b16 v[174:175], v186 offset:9216
    v_xor_b32 v191, 32, v186
    v_mfma_f32_16x16x32_bf16 v[208:211], v[176:179], v[144:147], v[208:211]
    ds_read_b64_tr_b16 v[172:173], v186 offset:8192
    v_mfma_f32_16x16x32_bf16 v[216:219], v[176:179], v[148:151], v[216:219]
    s_waitcnt lgkmcnt(8)
    ds_read_b64_tr_b16 v[178:179], v191 offset:1024
    v_mfma_f32_16x16x32_bf16 v[208:211], v[180:183], v[152:155], v[208:211]
    ds_read_b64_tr_b16 v[176:177], v191 offset:0
    v_mfma_f32_16x16x32_bf16 v[216:219], v[180:183], v[156:159], v[216:219]
    s_waitcnt lgkmcnt(8)
    ds_read_b64_tr_b16 v[182:183], v191 offset:9216
    v_cvt_pk_bf16_f32 v192, v192, v193
    v_cvt_pk_bf16_f32 v193, v194, v195
    v_cvt_pk_bf16_f32 v194, v196, v197
    v_cvt_pk_bf16_f32 v195, v198, v199
    v_cvt_pk_bf16_f32 v196, v200, v201
    v_cvt_pk_bf16_f32 v197, v202, v203
    v_cvt_pk_bf16_f32 v198, v204, v205
    v_cvt_pk_bf16_f32 v199, v206, v207
    v_permlane16_swap_b32 v192, v194
    v_permlane16_swap_b32 v193, v195
    v_permlane16_swap_b32 v196, v198
    v_permlane16_swap_b32 v197, v199
    v_mfma_f32_16x16x32_bf16 v[212:215], v[160:163], v[144:147], v[212:215]
    ds_read_b64_tr_b16 v[180:181], v191 offset:8192
    v_mfma_f32_16x16x32_bf16 v[220:223], v[160:163], v[148:151], v[220:223]
    s_waitcnt lgkmcnt(8)
    ds_read_b64_tr_b16 v[162:163], v187 offset:1024
    buffer_store_dwordx4 v[192:195], v189, s[16:19], s56 offen offset:0 sc1
    buffer_store_dwordx4 v[196:199], v189, s[16:19], s56 offen offset:256 sc1
    v_add_u32 v184, s55, v184
    v_mfma_f32_16x16x32_bf16 v[212:215], v[164:167], v[152:155], v[212:215]
    ds_read_b64_tr_b16 v[160:161], v187 offset:0
    v_mfma_f32_16x16x32_bf16 v[220:223], v[164:167], v[156:159], v[220:223]
    s_waitcnt lgkmcnt(8)
    ds_read_b64_tr_b16 v[166:167], v187 offset:9216
    v_xor_b32 v191, 32, v187
    v_mfma_f32_16x16x32_bf16 v[224:227], v[168:171], v[144:147], v[224:227]
    ds_read_b64_tr_b16 v[164:165], v187 offset:8192
    v_mfma_f32_16x16x32_bf16 v[232:235], v[168:171], v[148:151], v[232:235]
    s_waitcnt lgkmcnt(8)
    ds_read_b64_tr_b16 v[170:171], v191 offset:1024
    v_add_u32 v185, s55, v185
    v_mfma_f32_16x16x32_bf16 v[224:227], v[172:175], v[152:155], v[224:227]
    ds_read_b64_tr_b16 v[168:169], v191 offset:0
    v_mfma_f32_16x16x32_bf16 v[232:235], v[172:175], v[156:159], v[232:235]
    s_waitcnt lgkmcnt(8)
    ds_read_b64_tr_b16 v[174:175], v191 offset:9216
    v_cvt_pk_bf16_f32 v200, v208, v209
    v_cvt_pk_bf16_f32 v201, v210, v211
    v_cvt_pk_bf16_f32 v202, v212, v213
    v_cvt_pk_bf16_f32 v203, v214, v215
    v_cvt_pk_bf16_f32 v204, v216, v217
    v_cvt_pk_bf16_f32 v205, v218, v219
    v_cvt_pk_bf16_f32 v206, v220, v221
    v_cvt_pk_bf16_f32 v207, v222, v223
    v_permlane16_swap_b32 v200, v202
    v_permlane16_swap_b32 v201, v203
    v_permlane16_swap_b32 v204, v206
    v_permlane16_swap_b32 v205, v207
    v_add_u32 v186, s55, v186
    v_mfma_f32_16x16x32_bf16 v[228:231], v[176:179], v[144:147], v[228:231]
    ds_read_b64_tr_b16 v[172:173], v191 offset:8192
    v_mfma_f32_16x16x32_bf16 v[236:239], v[176:179], v[148:151], v[236:239]
    s_waitcnt lgkmcnt(8)
    s_cbranch_scc0 LG_q_xa9
LG_q_xb9:
    buffer_store_dwordx4 v[200:203], v189, s[16:19], s56 offen offset:2048 sc1
    buffer_store_dwordx4 v[204:207], v189, s[16:19], s56 offen offset:2304 sc1
    v_add_u32 v187, s55, v187
    v_mfma_f32_16x16x32_bf16 v[228:231], v[180:183], v[152:155], v[228:231]
    v_mfma_f32_16x16x32_bf16 v[236:239], v[180:183], v[156:159], v[236:239]
    s_waitcnt lgkmcnt(6)
    s_cbranch_scc0 LG_q_np
    s_barrier
LG_q_np:
    v_mfma_f32_16x16x32_bf16 v[240:243], v[160:163], v[144:147], v[240:243]
    v_mfma_f32_16x16x32_bf16 v[248:251], v[160:163], v[148:151], v[248:251]
    s_waitcnt lgkmcnt(4)
    v_mfma_f32_16x16x32_bf16 v[240:243], v[164:167], v[152:155], v[240:243]
    v_mfma_f32_16x16x32_bf16 v[248:251], v[164:167], v[156:159], v[248:251]
    s_waitcnt lgkmcnt(2)
    s_nop 1
    v_cvt_pk_bf16_f32 v208, v224, v225
    v_cvt_pk_bf16_f32 v209, v226, v227
    v_cvt_pk_bf16_f32 v210, v228, v229
    v_cvt_pk_bf16_f32 v211, v230, v231
    v_cvt_pk_bf16_f32 v212, v232, v233
    v_cvt_pk_bf16_f32 v213, v234, v235
    v_cvt_pk_bf16_f32 v214, v236, v237
    v_cvt_pk_bf16_f32 v215, v238, v239
    v_permlane16_swap_b32 v208, v210
    v_permlane16_swap_b32 v209, v211
    v_permlane16_swap_b32 v212, v214
    v_permlane16_swap_b32 v213, v215
    v_mfma_f32_16x16x32_bf16 v[244:247], v[168:171], v[144:147], v[244:247]
    v_mfma_f32_16x16x32_bf16 v[252:255], v[168:171], v[148:151], v[252:255]
    s_waitcnt lgkmcnt(0)
    buffer_store_dwordx4 v[208:211], v189, s[16:19], s57 offen offset:0 sc1
    buffer_store_dwordx4 v[212:215], v189, s[16:19], s57 offen offset:256 sc1
    v_mfma_f32_16x16x32_bf16 v[244:247], v[172:175], v[152:155], v[244:247]
    v_mfma_f32_16x16x32_bf16 v[252:255], v[172:175], v[156:159], v[252:255]
    s_cbranch_scc1 LG_q_nopre
    ds_read_b64_tr_b16 v[162:163], v184 offset:1024
    ds_read_b64_tr_b16 v[160:161], v184 offset:0
    v_xor_b32 v191, 32, v184
    ds_read_b64_tr_b16 v[166:167], v191 offset:1024
    ds_read_b64_tr_b16 v[164:165], v191 offset:0
    ds_read_b64_tr_b16 v[170:171], v185 offset:1024
    ds_read_b64_tr_b16 v[168:169], v185 offset:0
    v_xor_b32 v191, 32, v185
    ds_read_b64_tr_b16 v[174:175], v191 offset:1024
    ds_read_b64_tr_b16 v[172:173], v191 offset:0
    ds_read_b64_tr_b16 v[178:179], v186 offset:1024
    ds_read_b64_tr_b16 v[176:177], v186 offset:0
    v_xor_b32 v191, 32, v186
    ds_read_b64_tr_b16 v[182:183], v191 offset:1024
LG_q_nopre:
    s_nop 6
    v_cvt_pk_bf16_f32 v216, v240, v241
    v_cvt_pk_bf16_f32 v217, v242, v243
    v_cvt_pk_bf16_f32 v218, v244, v245
    v_cvt_pk_bf16_f32 v219, v246, v247
    v_cvt_pk_bf16_f32 v220, v248, v249
    v_cvt_pk_bf16_f32 v221, v250, v251
    v_cvt_pk_bf16_f32 v222, v252, v253
    v_cvt_pk_bf16_f32 v223, v254, v255
    v_permlane16_swap_b32 v216, v218
    v_permlane16_swap_b32 v217, v219
    v_permlane16_swap_b32 v220, v222
    v_permlane16_swap_b32 v221, v223
    buffer_store_dwordx4 v[216:219], v189, s[16:19], s57 offen offset:2048 sc1
    buffer_store_dwordx4 v[220:223], v189, s[16:19], s57 offen offset:2304 sc1
    s_cbranch_scc1 LG_done
    s_mov_b32 s99, 1
    s_cmp_ge_u32 s45, 5
    s_cselect_b32 s47, 6, 5
    s_add_u32 s96, s96, s47
    s_add_u32 s97, s97, s47
    s_add_u32 s56, s56, 20480
    s_add_u32 s57, s57, 20480
    s_mov_b32 s36, 0
    s_branch LG_q_body
LG_q_xa0:
    s_lshl_b32 s47, s41, 8
    s_add_u32 s47, s47, s2
    s_sub_u32 s47, s47, 240
    s_cmp_lt_u32 s47, 16
    s_cbranch_scc0 LG_q_cleared
    s_lshl_b32 s47, s47, 12
    s_add_u32 s47, s47, 22609920
    v_mbcnt_lo_u32_b32 v190, -1, 0
    v_lshlrev_b32 v190, 7, v190
    v_mov_b32 v191, 0
    s_mov_b32 exec_hi, 0
    buffer_store_dword v191, v190, s[16:19], s47 offen sc1
    s_mov_b64 exec, -1
LG_q_cleared:
    v_add_u32 v188, 32768, v188
    v_xor_b32 v24, 64, v188
    ds_read_b128 v[16:19], v188 offset:0
    ds_read_b128 v[20:23], v188 offset:2048
    ds_read_b128 v[28:31], v24 offset:2048
    ds_read_b128 v[24:27], v24 offset:0
    s_branch LG_q_xb0
LG_q_xa1:
    v_add_u32 v188, 4294918144, v188
    v_xor_b32 v40, 64, v188
    s_barrier
    ds_read_b128 v[32:35], v188 offset:0
    ds_read_b128 v[36:39], v188 offset:2048
    ds_read_b128 v[44:47], v40 offset:2048
    ds_read_b128 v[40:43], v40 offset:0
    s_branch LG_q_xb1
LG_q_xa2:
    v_add_u32 v188, 4294885376, v188
    v_xor_b32 v56, 64, v188
    s_barrier
    ds_read_b128 v[48:51], v188 offset:0
    ds_read_b128 v[52:55], v188 offset:2048
    ds_read_b128 v[60:63], v56 offset:2048
    ds_read_b128 v[56:59], v56 offset:0
    s_branch LG_q_xb2
LG_q_xa3:
    s_waitcnt vmcnt(0)
    s_lshl_b32 s47, s41, 8
    s_add_u32 s47, s47, s2
    s_sub_u32 s47, s47, 240
    s_cmp_lt_u32 s47, 16
    s_cbranch_scc0 LG_q_nocount
    s_lshl_b32 s47, s47, 4
    v_mov_b32 v190, 0
    v_mov_b32 v191, 1
    s_mov_b64 exec, 1
    buffer_atomic_add v191, v190, s[24:27], s47 offen offset:12 sc1
    s_mov_b64 exec, -1
LG_q_nocount:
    v_mov_b32 v190, 4
    v_add_u32 v188, 32768, v188
    v_xor_b32 v72, 64, v188
    s_barrier
    ds_read_b128 v[64:67], v188 offset:0
    ds_read_b128 v[68:71], v188 offset:2048
    ds_read_b128 v[76:79], v72 offset:2048
    ds_read_b128 v[72:75], v72 offset:0
    s_branch LG_q_xb3
LG_q_xa4:
    v_add_u32 v188, 65536, v188
    v_xor_b32 v88, 64, v188
    s_barrier
    ds_read_b128 v[80:83], v188 offset:0
    ds_read_b128 v[84:87], v188 offset:2048
    ds_read_b128 v[92:95], v88 offset:2048
    ds_read_b128 v[88:91], v88 offset:0
    s_branch LG_q_xb4
LG_q_xa5:
    v_add_u32 v188, 32768, v188
    v_xor_b32 v104, 64, v188
    ds_read_b128 v[96:99], v188 offset:0
    ds_read_b128 v[100:103], v188 offset:2048
    ds_read_b128 v[108:111], v104 offset:2048
    ds_read_b128 v[104:107], v104 offset:0
    s_branch LG_q_xb5
LG_q_xa6:
    v_add_u32 v188, 4294918144, v188
    v_xor_b32 v120, 64, v188
    s_barrier
    ds_read_b128 v[112:115], v188 offset:0
    ds_read_b128 v[116:119], v188 offset:2048
    ds_read_b128 v[124:127], v120 offset:2048
    ds_read_b128 v[120:123], v120 offset:0
    s_branch LG_q_xb6
LG_q_xa7:
    v_add_u32 v188, 4294885376, v188
    v_xor_b32 v136, 64, v188
    s_barrier
    ds_read_b128 v[128:131], v188 offset:0
    ds_read_b128 v[132:135], v188 offset:2048
    ds_read_b128 v[140:143], v136 offset:2048
    ds_read_b128 v[136:139], v136 offset:0
    s_branch LG_q_xb7
LG_q_xa8:
    v_add_u32 v188, 32768, v188
    v_xor_b32 v152, 64, v188
    s_barrier
    ds_read_b128 v[144:147], v188 offset:0
    ds_read_b128 v[148:151], v188 offset:2048
    ds_read_b128 v[156:159], v152 offset:2048
    ds_read_b128 v[152:155], v152 offset:0
    s_branch LG_q_xb8
LG_q_xa9:
    s_barrier
    s_branch LG_q_xb9
LG_q_da0:
    s_waitcnt vmcnt(0)
    s_mov_b64 exec, 1
    ds_add_u32 v190, v190 offset:32764
    s_mov_b64 exec, -1
    s_mov_b32 s36, 1
    s_branch LG_q_db0
LG_q_da1:
    s_waitcnt vmcnt(0)
    s_mov_b64 exec, 1
    ds_add_u32 v190, v190 offset:32764
    s_mov_b64 exec, -1
    s_mov_b32 s36, 1
    s_branch LG_q_db1
LG_q_da2:
    s_waitcnt vmcnt(0)
    s_mov_b64 exec, 1
    ds_add_u32 v190, v190 offset:32764
    s_mov_b64 exec, -1
    s_mov_b32 s36, 1
    s_branch LG_q_db2
LG_q_da3:
    s_waitcnt vmcnt(0)
    s_mov_b64 exec, 1
    ds_add_u32 v190, v190 offset:32764
    s_mov_b64 exec, -1
    s_mov_b32 s36, 1
    s_branch LG_q_db3
LG_q_da4:
    s_waitcnt vmcnt(0)
    s_mov_b64 exec, 1
    ds_add_u32 v190, v190 offset:32764
    s_mov_b64 exec, -1
    s_mov_b32 s36, 1
    s_branch LG_q_db4
LG_vtype:
    v_and_b32 v11, 7, v8
    v_lshrrev_b32 v10, 1, v11
    v_xor_b32 v10, v10, v9
    v_lshlrev_b32 v10, 4, v10
    v_lshl_add_u32 v10, v11, 7, v10
    v_and_b32 v11, 8, v8
    v_lshl_add_u32 v10, v11, 8, v10
    v_add_u32 v188, s48, v10
    v_mul_u32_u24 v10, 10240, v9
    v_lshl_add_u32 v189, v8, 4, v10
    s_lshl_b32 s56, s96, 10
    s_add_u32 s56, s56, 5222400
    s_add_u32 s56, s56, s47
    s_barrier
    s_mov_b32 s36, 1
    v_xor_b32 v8, 64, v188
    ds_read_b128 v[0:3], v188 offset:0
    ds_read_b128 v[4:7], v8 offset:1024
    ds_read_b128 v[12:15], v188 offset:1024
    ds_read_b128 v[8:11], v8 offset:0
    ds_read_b64_tr_b16 v[162:163], v184 offset:1024
    ds_read_b64_tr_b16 v[160:161], v184 offset:0
    v_xor_b32 v191, 32, v184
    ds_read_b64_tr_b16 v[166:167], v191 offset:1024
    ds_read_b64_tr_b16 v[164:165], v191 offset:0
    ds_read_b64_tr_b16 v[170:171], v185 offset:1024
    ds_read_b64_tr_b16 v[168:169], v185 offset:0
    v_xor_b32 v191, 32, v185
    ds_read_b64_tr_b16 v[174:175], v191 offset:1024
    ds_read_b64_tr_b16 v[172:173], v191 offset:0
    ds_read_b64_tr_b16 v[178:179], v186 offset:1024
    ds_read_b64_tr_b16 v[176:177], v186 offset:0
    v_xor_b32 v191, 32, v186
    ds_read_b64_tr_b16 v[182:183], v191 offset:1024
LG_v_body:
    s_waitcnt lgkmcnt(9)
    v_mfma_f32_16x16x32_bf16 v[192:195], v[0:3], v[160:163], 0
    s_cmp_eq_u32 s99, 1
    ds_read_b64_tr_b16 v[180:181], v191 offset:0
    v_mfma_f32_16x16x32_bf16 v[196:199], v[4:7], v[160:163], 0
    s_waitcnt lgkmcnt(8)
    ds_read_b64_tr_b16 v[162:163], v187 offset:1024
    v_xor_b32 v191, 32, v187
    v_mfma_f32_16x16x32_bf16 v[200:203], v[0:3], v[164:167], 0
    s_mov_b32 s55, 4294918144
    ds_read_b64_tr_b16 v[160:161], v187 offset:0
    v_mfma_f32_16x16x32_bf16 v[204:207], v[4:7], v[164:167], 0
    s_waitcnt lgkmcnt(8)
    ds_read_b64_tr_b16 v[166:167], v191 offset:1024
    v_mfma_f32_16x16x32_bf16 v[208:211], v[0:3], v[168:171], 0
    s_cmov_b32 s55, 16384
    ds_read_b64_tr_b16 v[164:165], v191 offset:0
    v_mfma_f32_16x16x32_bf16 v[212:215], v[4:7], v[168:171], 0
    s_waitcnt lgkmcnt(8)
    ds_read_b64_tr_b16 v[170:171], v184 offset:9216
    v_xor_b32 v191, 32, v184
    v_mfma_f32_16x16x32_bf16 v[216:219], v[0:3], v[172:175], 0
    ds_read_b64_tr_b16 v[168:169], v184 offset:8192
    v_mfma_f32_16x16x32_bf16 v[220:223], v[4:7], v[172:175], 0
    s_waitcnt lgkmcnt(8)
    ds_read_b64_tr_b16 v[174:175], v191 offset:9216
    v_add_u32 v184, s55, v184
    v_mfma_f32_16x16x32_bf16 v[224:227], v[0:3], v[176:179], 0
    ds_read_b64_tr_b16 v[172:173], v191 offset:8192
    v_mfma_f32_16x16x32_bf16 v[228:231], v[4:7], v[176:179], 0
    s_waitcnt lgkmcnt(8)
    ds_read_b64_tr_b16 v[178:179], v185 offset:9216
    v_xor_b32 v191, 32, v185
    v_mfma_f32_16x16x32_bf16 v[232:235], v[0:3], v[180:183], 0
    ds_read_b64_tr_b16 v[176:177], v185 offset:8192
    v_mfma_f32_16x16x32_bf16 v[236:239], v[4:7], v[180:183], 0
    s_waitcnt lgkmcnt(8)
    ds_read_b64_tr_b16 v[182:183], v191 offset:9216
    v_add_u32 v185, s55, v185
    v_mfma_f32_16x16x32_bf16 v[240:243], v[0:3], v[160:163], 0
    ds_read_b64_tr_b16 v[180:181], v191 offset:8192
    v_mfma_f32_16x16x32_bf16 v[244:247], v[4:7], v[160:163], 0
    s_waitcnt lgkmcnt(8)
    ds_read_b64_tr_b16 v[162:163], v186 offset:9216
    v_xor_b32 v191, 32, v186
    v_mfma_f32_16x16x32_bf16 v[248:251], v[0:3], v[164:167], 0
    ds_read_b64_tr_b16 v[160:161], v186 offset:8192
    v_mfma_f32_16x16x32_bf16 v[252:255], v[4:7], v[164:167], 0
    s_waitcnt lgkmcnt(8)
    ds_read_b64_tr_b16 v[166:167], v191 offset:9216
    v_add_u32 v186, s55, v186
    v_mfma_f32_16x16x32_bf16 v[192:195], v[8:11], v[168:171], v[192:195]
    ds_read_b64_tr_b16 v[164:165], v191 offset:8192
    v_mfma_f32_16x16x32_bf16 v[196:199], v[12:15], v[168:171], v[196:199]
    s_waitcnt lgkmcnt(8)
    ds_read_b64_tr_b16 v[170:171], v187 offset:9216
    v_xor_b32 v191, 32, v187
    v_mfma_f32_16x16x32_bf16 v[200:203], v[8:11], v[172:175], v[200:203]
    ds_read_b64_tr_b16 v[168:169], v187 offset:8192
    v_mfma_f32_16x16x32_bf16 v[204:207], v[12:15], v[172:175], v[204:207]
    s_waitcnt lgkmcnt(8)
    ds_read_b64_tr_b16 v[174:175], v191 offset:9216
    v_add_u32 v187, s55, v187
    v_mfma_f32_16x16x32_bf16 v[208:211], v[8:11], v[176:179], v[208:211]
    ds_read_b64_tr_b16 v[172:173], v191 offset:8192
    v_mfma_f32_16x16x32_bf16 v[212:215], v[12:15], v[176:179], v[212:215]
    s_waitcnt lgkmcnt(8)
    s_barrier
    s_cbranch_scc0 LG_v_xa0
LG_v_xb0:
    ds_read_b64_tr_b16 v[178:179], v184 offset:1024
    v_xor_b32 v191, 32, v184
    v_mfma_f32_16x16x32_bf16 v[216:219], v[8:11], v[180:183], v[216:219]
    ds_read_b64_tr_b16 v[176:177], v184 offset:0
    v_mfma_f32_16x16x32_bf16 v[220:223], v[12:15], v[180:183], v[220:223]
    s_waitcnt lgkmcnt(8)
    ds_read_b64_tr_b16 v[182:183], v191 offset:1024
    v_mfma_f32_16x16x32_bf16 v[224:227], v[8:11], v[160:163], v[224:227]
    s_getreg_b32 s47, hwreg(HW_REG_IB_STS, 0, 4)
    ds_read_b64_tr_b16 v[180:181], v191 offset:0
    v_mfma_f32_16x16x32_bf16 v[228:231], v[12:15], v[160:163], v[228:231]
    s_waitcnt lgkmcnt(8)
    ds_read_b64_tr_b16 v[162:163], v185 offset:1024
    v_xor_b32 v191, 32, v185
    v_mfma_f32_16x16x32_bf16 v[232:235], v[8:11], v[164:167], v[232:235]
    s_or_b32 s47, s47, s36
    ds_read_b64_tr_b16 v[160:161], v185 offset:0
    v_mfma_f32_16x16x32_bf16 v[236:239], v[12:15], v[164:167], v[236:239]
    s_waitcnt lgkmcnt(8)
    ds_read_b64_tr_b16 v[166:167], v191 offset:1024
    v_mfma_f32_16x16x32_bf16 v[240:243], v[8:11], v[168:171], v[240:243]
    s_cbranch_scc0 LG_v_da0
LG_v_db0:
    ds_read_b64_tr_b16 v[164:165], v191 offset:0
    v_mfma_f32_16x16x32_bf16 v[244:247], v[12:15], v[168:171], v[244:247]
    s_waitcnt lgkmcnt(8)
    ds_read_b64_tr_b16 v[170:171], v186 offset:1024
    v_xor_b32 v191, 32, v186
    v_mfma_f32_16x16x32_bf16 v[248:251], v[8:11], v[172:175], v[248:251]
    ds_read_b64_tr_b16 v[168:169], v186 offset:0
    v_mfma_f32_16x16x32_bf16 v[252:255], v[12:15], v[172:175], v[252:255]
    s_waitcnt lgkmcnt(8)
    ds_read_b64_tr_b16 v[174:175], v191 offset:1024
    v_mfma_f32_16x16x32_bf16 v[192:195], v[16:19], v[176:179], v[192:195]
    s_cmp_eq_u32 s99, 1
    ds_read_b64_tr_b16 v[172:173], v191 offset:0
    v_mfma_f32_16x16x32_bf16 v[196:199], v[20:23], v[176:179], v[196:199]
    s_waitcnt lgkmcnt(8)
    ds_read_b64_tr_b16 v[178:179], v187 offset:1024
    v_xor_b32 v191, 32, v187
    v_mfma_f32_16x16x32_bf16 v[200:203], v[16:19], v[180:183], v[200:203]
    s_mov_b32 s55, 4294885376
    ds_read_b64_tr_b16 v[176:177], v187 offset:0
    v_mfma_f32_16x16x32_bf16 v[204:207], v[20:23], v[180:183], v[204:207]
    s_waitcnt lgkmcnt(8)
    ds_read_b64_tr_b16 v[182:183], v191 offset:1024
    v_mfma_f32_16x16x32_bf16 v[208:211], v[16:19], v[160:163], v[208:211]
    s_cmov_b32 s55, 16384
    ds_read_b64_tr_b16 v[180:181], v191 offset:0
    v_mfma_f32_16x16x32_bf16 v[212:215], v[20:23], v[160:163], v[212:215]
    s_waitcnt lgkmcnt(8)
    ds_read_b64_tr_b16 v[162:163], v184 offset:9216
    v_xor_b32 v191, 32, v184
    v_mfma_f32_16x16x32_bf16 v[216:219], v[16:19], v[164:167], v[216:219]
    ds_read_b64_tr_b16 v[160:161], v184 offset:8192
    v_mfma_f32_16x16x32_bf16 v[220:223], v[20:23], v[164:167], v[220:223]
    s_waitcnt lgkmcnt(8)
    ds_read_b64_tr_b16 v[166:167], v191 offset:9216
    v_add_u32 v184, s55, v184
    v_mfma_f32_16x16x32_bf16 v[224:227], v[16:19], v[168:171], v[224:227]
    ds_read_b64_tr_b16 v[164:165], v191 offset:8192
    v_mfma_f32_16x16x32_bf16 v[228:231], v[20:23], v[168:171], v[228:231]
    s_waitcnt lgkmcnt(8)
    ds_read_b64_tr_b16 v[170:171], v185 offset:9216
    v_xor_b32 v191, 32, v185
    v_mfma_f32_16x16x32_bf16 v[232:235], v[16:19], v[172:175], v[232:235]
    ds_read_b64_tr_b16 v[168:169], v185 offset:8192
    v_mfma_f32_16x16x32_bf16 v[236:239], v[20:23], v[172:175], v[236:239]
    s_waitcnt lgkmcnt(8)
    ds_read_b64_tr_b16 v[174:175], v191 offset:9216
    v_add_u32 v185, s55, v185
    v_mfma_f32_16x16x32_bf16 v[240:243], v[16:19], v[176:179], v[240:243]
    ds_read_b64_tr_b16 v[172:173], v191 offset:8192
    v_mfma_f32_16x16x32_bf16 v[244:247], v[20:23], v[176:179], v[244:247]
    s_waitcnt lgkmcnt(8)
    ds_read_b64_tr_b16 v[178:179], v186 offset:9216
    v_xor_b32 v191, 32, v186
    v_mfma_f32_16x16x32_bf16 v[248:251], v[16:19], v[180:183], v[248:251]
    ds_read_b64_tr_b16 v[176:177], v186 offset:8192
    v_mfma_f32_16x16x32_bf16 v[252:255], v[20:23], v[180:183], v[252:255]
    s_waitcnt lgkmcnt(8)
    ds_read_b64_tr_b16 v[182:183], v191 offset:9216
    v_add_u32 v186, s55, v186
    v_mfma_f32_16x16x32_bf16 v[192:195], v[24:27], v[160:163], v[192:195]
    ds_read_b64_tr_b16 v[180:181], v191 offset:8192
    v_mfma_f32_16x16x32_bf16 v[196:199], v[28:31], v[160:163], v[196:199]
    s_waitcnt lgkmcnt(8)
    ds_read_b64_tr_b16 v[162:163], v187 offset:9216
    v_xor_b32 v191, 32, v187
    v_mfma_f32_16x16x32_bf16 v[200:203], v[24:27], v[164:167], v[200:203]
    ds_read_b64_tr_b16 v[160:161], v187 offset:8192
    v_mfma_f32_16x16x32_bf16 v[204:207], v[28:31], v[164:167], v[204:207]
    s_waitcnt lgkmcnt(8)
    ds_read_b64_tr_b16 v[166:167], v191 offset:9216
    v_add_u32 v187, s55, v187
    v_mfma_f32_16x16x32_bf16 v[208:211], v[24:27], v[168:171], v[208:211]
    ds_read_b64_tr_b16 v[164:165], v191 offset:8192
    v_mfma_f32_16x16x32_bf16 v[212:215], v[28:31], v[168:171], v[212:215]
    s_waitcnt lgkmcnt(8)
    s_cbranch_scc0 LG_v_xa1
LG_v_xb1:
    ds_read_b64_tr_b16 v[170:171], v184 offset:1024
    v_xor_b32 v191, 32, v184
    v_mfma_f32_16x16x32_bf16 v[216:219], v[24:27], v[172:175], v[216:219]
    ds_read_b64_tr_b16 v[168:169], v184 offset:0
    v_mfma_f32_16x16x32_bf16 v[220:223], v[28:31], v[172:175], v[220:223]
    s_waitcnt lgkmcnt(8)
    ds_read_b64_tr_b16 v[174:175], v191 offset:1024
    v_mfma_f32_16x16x32_bf16 v[224:227], v[24:27], v[176:179], v[224:227]
    s_getreg_b32 s47, hwreg(HW_REG_IB_STS, 0, 4)
    ds_read_b64_tr_b16 v[172:173], v191 offset:0
    v_mfma_f32_16x16x32_bf16 v[228:231], v[28:31], v[176:179], v[228:231]
    s_waitcnt lgkmcnt(8)
    ds_read_b64_tr_b16 v[178:179], v185 offset:1024
    v_xor_b32 v191, 32, v185
    v_mfma_f32_16x16x32_bf16 v[232:235], v[24:27], v[180:183], v[232:235]
    s_or_b32 s47, s47, s36
    ds_read_b64_tr_b16 v[176:177], v185 offset:0
    v_mfma_f32_16x16x32_bf16 v[236:239], v[28:31], v[180:183], v[236:239]
    s_waitcnt lgkmcnt(8)
    ds_read_b64_tr_b16 v[182:183], v191 offset:1024
    v_mfma_f32_16x16x32_bf16 v[240:243], v[24:27], v[160:163], v[240:243]
    s_cbranch_scc0 LG_v_da1
LG_v_db1:
    ds_read_b64_tr_b16 v[180:181], v191 offset:0
    v_mfma_f32_16x16x32_bf16 v[244:247], v[28:31], v[160:163], v[244:247]
    s_waitcnt lgkmcnt(8)
    ds_read_b64_tr_b16 v[162:163], v186 offset:1024
    v_xor_b32 v191, 32, v186
    v_mfma_f32_16x16x32_bf16 v[248:251], v[24:27], v[164:167], v[248:251]
    ds_read_b64_tr_b16 v[160:161], v186 offset:0
    v_mfma_f32_16x16x32_bf16 v[252:255], v[28:31], v[164:167], v[252:255]
    s_waitcnt lgkmcnt(8)
    ds_read_b64_tr_b16 v[166:167], v191 offset:1024
    v_mfma_f32_16x16x32_bf16 v[192:195], v[32:35], v[168:171], v[192:195]
    s_cmp_eq_u32 s99, 1
    ds_read_b64_tr_b16 v[164:165], v191 offset:0
    v_mfma_f32_16x16x32_bf16 v[196:199], v[36:39], v[168:171], v[196:199]
    s_waitcnt lgkmcnt(8)
    ds_read_b64_tr_b16 v[170:171], v187 offset:1024
    v_xor_b32 v191, 32, v187
    v_mfma_f32_16x16x32_bf16 v[200:203], v[32:35], v[172:175], v[200:203]
    s_mov_b32 s55, 32768
    ds_read_b64_tr_b16 v[168:169], v187 offset:0
    v_mfma_f32_16x16x32_bf16 v[204:207], v[36:39], v[172:175], v[204:207]
    s_waitcnt lgkmcnt(8)
    ds_read_b64_tr_b16 v[174:175], v191 offset:1024
    v_mfma_f32_16x16x32_bf16 v[208:211], v[32:35], v[176:179], v[208:211]
    s_cmov_b32 s55, 4294901760
    ds_read_b64_tr_b16 v[172:173], v191 offset:0
    v_mfma_f32_16x16x32_bf16 v[212:215], v[36:39], v[176:179], v[212:215]
    s_waitcnt lgkmcnt(8)
    ds_read_b64_tr_b16 v[178:179], v184 offset:9216
    v_xor_b32 v191, 32, v184
    v_mfma_f32_16x16x32_bf16 v[216:219], v[32:35], v[180:183], v[216:219]
    ds_read_b64_tr_b16 v[176:177], v184 offset:8192
    v_mfma_f32_16x16x32_bf16 v[220:223], v[36:39], v[180:183], v[220:223]
    s_waitcnt lgkmcnt(8)
    ds_read_b64_tr_b16 v[182:183], v191 offset:9216
    v_add_u32 v184, s55, v184
    v_mfma_f32_16x16x32_bf16 v[224:227], v[32:35], v[160:163], v[224:227]
    ds_read_b64_tr_b16 v[180:181], v191 offset:8192
    v_mfma_f32_16x16x32_bf16 v[228:231], v[36:39], v[160:163], v[228:231]
    s_waitcnt lgkmcnt(8)
    ds_read_b64_tr_b16 v[162:163], v185 offset:9216
    v_xor_b32 v191, 32, v185
    v_mfma_f32_16x16x32_bf16 v[232:235], v[32:35], v[164:167], v[232:235]
    ds_read_b64_tr_b16 v[160:161], v185 offset:8192
    v_mfma_f32_16x16x32_bf16 v[236:239], v[36:39], v[164:167], v[236:239]
    s_waitcnt lgkmcnt(8)
    ds_read_b64_tr_b16 v[166:167], v191 offset:9216
    v_add_u32 v185, s55, v185
    v_mfma_f32_16x16x32_bf16 v[240:243], v[32:35], v[168:171], v[240:243]
    ds_read_b64_tr_b16 v[164:165], v191 offset:8192
    v_mfma_f32_16x16x32_bf16 v[244:247], v[36:39], v[168:171], v[244:247]
    s_waitcnt lgkmcnt(8)
    ds_read_b64_tr_b16 v[170:171], v186 offset:9216
    v_xor_b32 v191, 32, v186
    v_mfma_f32_16x16x32_bf16 v[248:251], v[32:35], v[172:175], v[248:251]
    ds_read_b64_tr_b16 v[168:169], v186 offset:8192
    v_mfma_f32_16x16x32_bf16 v[252:255], v[36:39], v[172:175], v[252:255]
    s_waitcnt lgkmcnt(8)
    ds_read_b64_tr_b16 v[174:175], v191 offset:9216
    v_add_u32 v186, s55, v186
    v_mfma_f32_16x16x32_bf16 v[192:195], v[40:43], v[176:179], v[192:195]
    ds_read_b64_tr_b16 v[172:173], v191 offset:8192
    v_mfma_f32_16x16x32_bf16 v[196:199], v[44:47], v[176:179], v[196:199]
    s_waitcnt lgkmcnt(8)
    ds_read_b64_tr_b16 v[178:179], v187 offset:9216
    v_xor_b32 v191, 32, v187
    v_mfma_f32_16x16x32_bf16 v[200:203], v[40:43], v[180:183], v[200:203]
    ds_read_b64_tr_b16 v[176:177], v187 offset:8192
    v_mfma_f32_16x16x32_bf16 v[204:207], v[44:47], v[180:183], v[204:207]
    s_waitcnt lgkmcnt(8)
    ds_read_b64_tr_b16 v[182:183], v191 offset:9216
    v_add_u32 v187, s55, v187
    v_mfma_f32_16x16x32_bf16 v[208:211], v[40:43], v[160:163], v[208:211]
    ds_read_b64_tr_b16 v[180:181], v191 offset:8192
    v_mfma_f32_16x16x32_bf16 v[212:215], v[44:47], v[160:163], v[212:215]
    s_waitcnt lgkmcnt(8)
    s_cbranch_scc0 LG_v_xa2
LG_v_xb2:
    ds_read_b64_tr_b16 v[162:163], v184 offset:1024
    v_xor_b32 v191, 32, v184
    v_mfma_f32_16x16x32_bf16 v[216:219], v[40:43], v[164:167], v[216:219]
    ds_read_b64_tr_b16 v[160:161], v184 offset:0
    v_mfma_f32_16x16x32_bf16 v[220:223], v[44:47], v[164:167], v[220:223]
    s_waitcnt lgkmcnt(8)
    ds_read_b64_tr_b16 v[166:167], v191 offset:1024
    v_mfma_f32_16x16x32_bf16 v[224:227], v[40:43], v[168:171], v[224:227]
    s_getreg_b32 s47, hwreg(HW_REG_IB_STS, 0, 4)
    ds_read_b64_tr_b16 v[164:165], v191 offset:0
    v_mfma_f32_16x16x32_bf16 v[228:231], v[44:47], v[168:171], v[228:231]
    s_waitcnt lgkmcnt(8)
    ds_read_b64_tr_b16 v[170:171], v185 offset:1024
    v_xor_b32 v191, 32, v185
    v_mfma_f32_16x16x32_bf16 v[232:235], v[40:43], v[172:175], v[232:235]
    s_or_b32 s47, s47, s36
    ds_read_b64_tr_b16 v[168:169], v185 offset:0
    v_mfma_f32_16x16x32_bf16 v[236:239], v[44:47], v[172:175], v[236:239]
    s_waitcnt lgkmcnt(8)
    ds_read_b64_tr_b16 v[174:175], v191 offset:1024
    v_mfma_f32_16x16x32_bf16 v[240:243], v[40:43], v[176:179], v[240:243]
    s_cbranch_scc0 LG_v_da2
LG_v_db2:
    ds_read_b64_tr_b16 v[172:173], v191 offset:0
    v_mfma_f32_16x16x32_bf16 v[244:247], v[44:47], v[176:179], v[244:247]
    s_waitcnt lgkmcnt(8)
    ds_read_b64_tr_b16 v[178:179], v186 offset:1024
    v_xor_b32 v191, 32, v186
    v_mfma_f32_16x16x32_bf16 v[248:251], v[40:43], v[180:183], v[248:251]
    ds_read_b64_tr_b16 v[176:177], v186 offset:0
    v_mfma_f32_16x16x32_bf16 v[252:255], v[44:47], v[180:183], v[252:255]
    s_waitcnt lgkmcnt(8)
    ds_read_b64_tr_b16 v[182:183], v191 offset:1024
    v_mfma_f32_16x16x32_bf16 v[192:195], v[48:51], v[160:163], v[192:195]
    s_cmp_eq_u32 s99, 1
    ds_read_b64_tr_b16 v[180:181], v191 offset:0
    v_mfma_f32_16x16x32_bf16 v[196:199], v[52:55], v[160:163], v[196:199]
    s_waitcnt lgkmcnt(8)
    ds_read_b64_tr_b16 v[162:163], v187 offset:1024
    v_xor_b32 v191, 32, v187
    v_mfma_f32_16x16x32_bf16 v[200:203], v[48:51], v[164:167], v[200:203]
    s_mov_b32 s55, 32768
    ds_read_b64_tr_b16 v[160:161], v187 offset:0
    v_mfma_f32_16x16x32_bf16 v[204:207], v[52:55], v[164:167], v[204:207]
    s_waitcnt lgkmcnt(8)
    ds_read_b64_tr_b16 v[166:167], v191 offset:1024
    v_mfma_f32_16x16x32_bf16 v[208:211], v[48:51], v[168:171], v[208:211]
    s_cmov_b32 s55, 16384
    ds_read_b64_tr_b16 v[164:165], v191 offset:0
    v_mfma_f32_16x16x32_bf16 v[212:215], v[52:55], v[168:171], v[212:215]
    s_waitcnt lgkmcnt(8)
    ds_read_b64_tr_b16 v[170:171], v184 offset:9216
    v_xor_b32 v191, 32, v184
    v_mfma_f32_16x16x32_bf16 v[216:219], v[48:51], v[172:175], v[216:219]
    ds_read_b64_tr_b16 v[168:169], v184 offset:8192
    v_mfma_f32_16x16x32_bf16 v[220:223], v[52:55], v[172:175], v[220:223]
    s_waitcnt lgkmcnt(8)
    ds_read_b64_tr_b16 v[174:175], v191 offset:9216
    v_add_u32 v184, s55, v184
    v_mfma_f32_16x16x32_bf16 v[224:227], v[48:51], v[176:179], v[224:227]
    ds_read_b64_tr_b16 v[172:173], v191 offset:8192
    v_mfma_f32_16x16x32_bf16 v[228:231], v[52:55], v[176:179], v[228:231]
    s_waitcnt lgkmcnt(8)
    ds_read_b64_tr_b16 v[178:179], v185 offset:9216
    v_xor_b32 v191, 32, v185
    v_mfma_f32_16x16x32_bf16 v[232:235], v[48:51], v[180:183], v[232:235]
    ds_read_b64_tr_b16 v[176:177], v185 offset:8192
    v_mfma_f32_16x16x32_bf16 v[236:239], v[52:55], v[180:183], v[236:239]
    s_waitcnt lgkmcnt(8)
    ds_read_b64_tr_b16 v[182:183], v191 offset:9216
    v_add_u32 v185, s55, v185
    v_mfma_f32_16x16x32_bf16 v[240:243], v[48:51], v[160:163], v[240:243]
    ds_read_b64_tr_b16 v[180:181], v191 offset:8192
    v_mfma_f32_16x16x32_bf16 v[244:247], v[52:55], v[160:163], v[244:247]
    s_waitcnt lgkmcnt(8)
    ds_read_b64_tr_b16 v[162:163], v186 offset:9216
    v_xor_b32 v191, 32, v186
    v_mfma_f32_16x16x32_bf16 v[248:251], v[48:51], v[164:167], v[248:251]
    ds_read_b64_tr_b16 v[160:161], v186 offset:8192
    v_mfma_f32_16x16x32_bf16 v[252:255], v[52:55], v[164:167], v[252:255]
    s_waitcnt lgkmcnt(8)
    ds_read_b64_tr_b16 v[166:167], v191 offset:9216
    v_add_u32 v186, s55, v186
    v_mfma_f32_16x16x32_bf16 v[192:195], v[56:59], v[168:171], v[192:195]
    ds_read_b64_tr_b16 v[164:165], v191 offset:8192
    v_mfma_f32_16x16x32_bf16 v[196:199], v[60:63], v[168:171], v[196:199]
    s_waitcnt lgkmcnt(8)
    ds_read_b64_tr_b16 v[170:171], v187 offset:9216
    v_xor_b32 v191, 32, v187
    v_mfma_f32_16x16x32_bf16 v[200:203], v[56:59], v[172:175], v[200:203]
    ds_read_b64_tr_b16 v[168:169], v187 offset:8192
    v_mfma_f32_16x16x32_bf16 v[204:207], v[60:63], v[172:175], v[204:207]
    s_waitcnt lgkmcnt(8)
    ds_read_b64_tr_b16 v[174:175], v191 offset:9216
    v_add_u32 v187, s55, v187
    v_mfma_f32_16x16x32_bf16 v[208:211], v[56:59], v[176:179], v[208:211]
    ds_read_b64_tr_b16 v[172:173], v191 offset:8192
    v_mfma_f32_16x16x32_bf16 v[212:215], v[60:63], v[176:179], v[212:215]
    s_waitcnt lgkmcnt(8)
    s_cbranch_scc0 LG_v_xa3
LG_v_xb3:
    ds_read_b64_tr_b16 v[178:179], v184 offset:1024
    v_xor_b32 v191, 32, v184
    v_mfma_f32_16x16x32_bf16 v[216:219], v[56:59], v[180:183], v[216:219]
    ds_read_b64_tr_b16 v[176:177], v184 offset:0
    v_mfma_f32_16x16x32_bf16 v[220:223], v[60:63], v[180:183], v[220:223]
    s_waitcnt lgkmcnt(8)
    ds_read_b64_tr_b16 v[182:183], v191 offset:1024
    v_mfma_f32_16x16x32_bf16 v[224:227], v[56:59], v[160:163], v[224:227]
    s_getreg_b32 s47, hwreg(HW_REG_IB_STS, 0, 4)
    ds_read_b64_tr_b16 v[180:181], v191 offset:0
    v_mfma_f32_16x16x32_bf16 v[228:231], v[60:63], v[160:163], v[228:231]
    s_waitcnt lgkmcnt(8)
    ds_read_b64_tr_b16 v[162:163], v185 offset:1024
    v_xor_b32 v191, 32, v185
    v_mfma_f32_16x16x32_bf16 v[232:235], v[56:59], v[164:167], v[232:235]
    s_or_b32 s47, s47, s36
    ds_read_b64_tr_b16 v[160:161], v185 offset:0
    v_mfma_f32_16x16x32_bf16 v[236:239], v[60:63], v[164:167], v[236:239]
    s_waitcnt lgkmcnt(8)
    ds_read_b64_tr_b16 v[166:167], v191 offset:1024
    v_mfma_f32_16x16x32_bf16 v[240:243], v[56:59], v[168:171], v[240:243]
    s_cbranch_scc0 LG_v_da3
LG_v_db3:
    ds_read_b64_tr_b16 v[164:165], v191 offset:0
    v_mfma_f32_16x16x32_bf16 v[244:247], v[60:63], v[168:171], v[244:247]
    s_waitcnt lgkmcnt(8)
    ds_read_b64_tr_b16 v[170:171], v186 offset:1024
    v_xor_b32 v191, 32, v186
    v_mfma_f32_16x16x32_bf16 v[248:251], v[56:59], v[172:175], v[248:251]
    ds_read_b64_tr_b16 v[168:169], v186 offset:0
    v_mfma_f32_16x16x32_bf16 v[252:255], v[60:63], v[172:175], v[252:255]
    s_waitcnt lgkmcnt(8)
    ds_read_b64_tr_b16 v[174:175], v191 offset:1024
    v_mfma_f32_16x16x32_bf16 v[192:195], v[64:67], v[176:179], v[192:195]
    s_cmp_eq_u32 s99, 1
    ds_read_b64_tr_b16 v[172:173], v191 offset:0
    v_mfma_f32_16x16x32_bf16 v[196:199], v[68:71], v[176:179], v[196:199]
    s_waitcnt lgkmcnt(8)
    ds_read_b64_tr_b16 v[178:179], v187 offset:1024
    v_xor_b32 v191, 32, v187
    v_mfma_f32_16x16x32_bf16 v[200:203], v[64:67], v[180:183], v[200:203]
    s_mov_b32 s55, 65536
    ds_read_b64_tr_b16 v[176:177], v187 offset:0
    v_mfma_f32_16x16x32_bf16 v[204:207], v[68:71], v[180:183], v[204:207]
    s_waitcnt lgkmcnt(8)
    ds_read_b64_tr_b16 v[182:183], v191 offset:1024
    v_mfma_f32_16x16x32_bf16 v[208:211], v[64:67], v[160:163], v[208:211]
    s_cmov_b32 s55, 4294868992
    ds_read_b64_tr_b16 v[180:181], v191 offset:0
    v_mfma_f32_16x16x32_bf16 v[212:215], v[68:71], v[160:163], v[212:215]
    s_waitcnt lgkmcnt(8)
    ds_read_b64_tr_b16 v[162:163], v184 offset:9216
    v_xor_b32 v191, 32, v184
    v_mfma_f32_16x16x32_bf16 v[216:219], v[64:67], v[164:167], v[216:219]
    ds_read_b64_tr_b16 v[160:161], v184 offset:8192
    v_mfma_f32_16x16x32_bf16 v[220:223], v[68:71], v[164:167], v[220:223]
    s_waitcnt lgkmcnt(8)
    ds_read_b64_tr_b16 v[166:167], v191 offset:9216
    v_add_u32 v184, s55, v184
    v_mfma_f32_16x16x32_bf16 v[224:227], v[64:67], v[168:171], v[224:227]
    ds_read_b64_tr_b16 v[164:165], v191 offset:8192
    v_mfma_f32_16x16x32_bf16 v[228:231], v[68:71], v[168:171], v[228:231]
    s_waitcnt lgkmcnt(8)
    ds_read_b64_tr_b16 v[170:171], v185 offset:9216
    v_xor_b32 v191, 32, v185
    v_mfma_f32_16x16x32_bf16 v[232:235], v[64:67], v[172:175], v[232:235]
    ds_read_b64_tr_b16 v[168:169], v185 offset:8192
    v_mfma_f32_16x16x32_bf16 v[236:239], v[68:71], v[172:175], v[236:239]
    s_waitcnt lgkmcnt(8)
    ds_read_b64_tr_b16 v[174:175], v191 offset:9216
    v_add_u32 v185, s55, v185
    v_mfma_f32_16x16x32_bf16 v[240:243], v[64:67], v[176:179], v[240:243]
    ds_read_b64_tr_b16 v[172:173], v191 offset:8192
    v_mfma_f32_16x16x32_bf16 v[244:247], v[68:71], v[176:179], v[244:247]
    s_waitcnt lgkmcnt(8)
    ds_read_b64_tr_b16 v[178:179], v186 offset:9216
    v_xor_b32 v191, 32, v186
    v_mfma_f32_16x16x32_bf16 v[248:251], v[64:67], v[180:183], v[248:251]
    ds_read_b64_tr_b16 v[176:177], v186 offset:8192
    v_mfma_f32_16x16x32_bf16 v[252:255], v[68:71], v[180:183], v[252:255]
    s_waitcnt lgkmcnt(8)
    ds_read_b64_tr_b16 v[182:183], v191 offset:9216
    v_add_u32 v186, s55, v186
    v_mfma_f32_16x16x32_bf16 v[192:195], v[72:75], v[160:163], v[192:195]
    ds_read_b64_tr_b16 v[180:181], v191 offset:8192
    v_mfma_f32_16x16x32_bf16 v[196:199], v[76:79], v[160:163], v[196:199]
    s_waitcnt lgkmcnt(8)
    ds_read_b64_tr_b16 v[162:163], v187 offset:9216
    v_xor_b32 v191, 32, v187
    v_mfma_f32_16x16x32_bf16 v[200:203], v[72:75], v[164:167], v[200:203]
    ds_read_b64_tr_b16 v[160:161], v187 offset:8192
    v_mfma_f32_16x16x32_bf16 v[204:207], v[76:79], v[164:167], v[204:207]
    s_waitcnt lgkmcnt(8)
    ds_read_b64_tr_b16 v[166:167], v191 offset:9216
    v_add_u32 v187, s55, v187
    v_mfma_f32_16x16x32_bf16 v[208:211], v[72:75], v[168:171], v[208:211]
    ds_read_b64_tr_b16 v[164:165], v191 offset:8192
    v_mfma_f32_16x16x32_bf16 v[212:215], v[76:79], v[168:171], v[212:215]
    s_waitcnt lgkmcnt(8)
    s_cbranch_scc0 LG_v_xa4
LG_v_xb4:
    ds_read_b64_tr_b16 v[170:171], v184 offset:1024
    v_xor_b32 v191, 32, v184
    v_mfma_f32_16x16x32_bf16 v[216:219], v[72:75], v[172:175], v[216:219]
    ds_read_b64_tr_b16 v[168:169], v184 offset:0
    v_mfma_f32_16x16x32_bf16 v[220:223], v[76:79], v[172:175], v[220:223]
    s_waitcnt lgkmcnt(8)
    ds_read_b64_tr_b16 v[174:175], v191 offset:1024
    v_mfma_f32_16x16x32_bf16 v[224:227], v[72:75], v[176:179], v[224:227]
    s_mov_b32 s47, 0
    ds_read_b64_tr_b16 v[172:173], v191 offset:0
    v_mfma_f32_16x16x32_bf16 v[228:231], v[76:79], v[176:179], v[228:231]
    s_waitcnt lgkmcnt(8)
    ds_read_b64_tr_b16 v[178:179], v185 offset:1024
    v_xor_b32 v191, 32, v185
    v_mfma_f32_16x16x32_bf16 v[232:235], v[72:75], v[180:183], v[232:235]
    s_or_b32 s47, s47, s36
    ds_read_b64_tr_b16 v[176:177], v185 offset:0
    v_mfma_f32_16x16x32_bf16 v[236:239], v[76:79], v[180:183], v[236:239]
    s_waitcnt lgkmcnt(8)
    ds_read_b64_tr_b16 v[182:183], v191 offset:1024
    v_mfma_f32_16x16x32_bf16 v[240:243], v[72:75], v[160:163], v[240:243]
    s_cbranch_scc0 LG_v_da4
LG_v_db4:
    ds_read_b64_tr_b16 v[180:181], v191 offset:0
    v_mfma_f32_16x16x32_bf16 v[244:247], v[76:79], v[160:163], v[244:247]
    s_waitcnt lgkmcnt(8)
    ds_read_b64_tr_b16 v[162:163], v186 offset:1024
    v_xor_b32 v191, 32, v186
    v_mfma_f32_16x16x32_bf16 v[248:251], v[72:75], v[164:167], v[248:251]
    ds_read_b64_tr_b16 v[160:161], v186 offset:0
    v_mfma_f32_16x16x32_bf16 v[252:255], v[76:79], v[164:167], v[252:255]
    s_waitcnt lgkmcnt(8)
    ds_read_b64_tr_b16 v[166:167], v191 offset:1024
    v_mfma_f32_16x16x32_bf16 v[192:195], v[80:83], v[168:171], v[192:195]
    s_cmp_eq_u32 s99, 1
    ds_read_b64_tr_b16 v[164:165], v191 offset:0
    v_mfma_f32_16x16x32_bf16 v[196:199], v[84:87], v[168:171], v[196:199]
    s_waitcnt lgkmcnt(8)
    ds_read_b64_tr_b16 v[170:171], v187 offset:1024
    v_xor_b32 v191, 32, v187
    v_mfma_f32_16x16x32_bf16 v[200:203], v[80:83], v[172:175], v[200:203]
    s_mov_b32 s55, 4294918144
    ds_read_b64_tr_b16 v[168:169], v187 offset:0
    v_mfma_f32_16x16x32_bf16 v[204:207], v[84:87], v[172:175], v[204:207]
    s_waitcnt lgkmcnt(8)
    ds_read_b64_tr_b16 v[174:175], v191 offset:1024
    v_mfma_f32_16x16x32_bf16 v[208:211], v[80:83], v[176:179], v[208:211]
    s_cmov_b32 s55, 16384
    ds_read_b64_tr_b16 v[172:173], v191 offset:0
    v_mfma_f32_16x16x32_bf16 v[212:215], v[84:87], v[176:179], v[212:215]
    s_waitcnt lgkmcnt(8)
    ds_read_b64_tr_b16 v[178:179], v184 offset:9216
    v_xor_b32 v191, 32, v184
    v_mfma_f32_16x16x32_bf16 v[216:219], v[80:83], v[180:183], v[216:219]
    ds_read_b64_tr_b16 v[176:177], v184 offset:8192
    v_mfma_f32_16x16x32_bf16 v[220:223], v[84:87], v[180:183], v[220:223]
    s_waitcnt lgkmcnt(8)
    ds_read_b64_tr_b16 v[182:183], v191 offset:9216
    v_add_u32 v184, s55, v184
    v_mfma_f32_16x16x32_bf16 v[224:227], v[80:83], v[160:163], v[224:227]
    ds_read_b64_tr_b16 v[180:181], v191 offset:8192
    v_mfma_f32_16x16x32_bf16 v[228:231], v[84:87], v[160:163], v[228:231]
    s_waitcnt lgkmcnt(8)
    ds_read_b64_tr_b16 v[162:163], v185 offset:9216
    v_xor_b32 v191, 32, v185
    v_mfma_f32_16x16x32_bf16 v[232:235], v[80:83], v[164:167], v[232:235]
    ds_read_b64_tr_b16 v[160:161], v185 offset:8192
    v_mfma_f32_16x16x32_bf16 v[236:239], v[84:87], v[164:167], v[236:239]
    s_waitcnt lgkmcnt(8)
    ds_read_b64_tr_b16 v[166:167], v191 offset:9216
    v_add_u32 v185, s55, v185
    v_mfma_f32_16x16x32_bf16 v[240:243], v[80:83], v[168:171], v[240:243]
    ds_read_b64_tr_b16 v[164:165], v191 offset:8192
    v_mfma_f32_16x16x32_bf16 v[244:247], v[84:87], v[168:171], v[244:247]
    s_waitcnt lgkmcnt(8)
    ds_read_b64_tr_b16 v[170:171], v186 offset:9216
    v_xor_b32 v191, 32, v186
    v_mfma_f32_16x16x32_bf16 v[248:251], v[80:83], v[172:175], v[248:251]
    ds_read_b64_tr_b16 v[168:169], v186 offset:8192
    v_mfma_f32_16x16x32_bf16 v[252:255], v[84:87], v[172:175], v[252:255]
    s_waitcnt lgkmcnt(8)
    ds_read_b64_tr_b16 v[174:175], v191 offset:9216
    v_add_u32 v186, s55, v186
    v_mfma_f32_16x16x32_bf16 v[192:195], v[88:91], v[176:179], v[192:195]
    ds_read_b64_tr_b16 v[172:173], v191 offset:8192
    v_mfma_f32_16x16x32_bf16 v[196:199], v[92:95], v[176:179], v[196:199]
    s_waitcnt lgkmcnt(8)
    ds_read_b64_tr_b16 v[178:179], v187 offset:9216
    v_xor_b32 v191, 32, v187
    v_mfma_f32_16x16x32_bf16 v[200:203], v[88:91], v[180:183], v[200:203]
    ds_read_b64_tr_b16 v[176:177], v187 offset:8192
    v_mfma_f32_16x16x32_bf16 v[204:207], v[92:95], v[180:183], v[204:207]
    s_waitcnt lgkmcnt(8)
    ds_read_b64_tr_b16 v[182:183], v191 offset:9216
    v_add_u32 v187, s55, v187
    v_mfma_f32_16x16x32_bf16 v[208:211], v[88:91], v[160:163], v[208:211]
    ds_read_b64_tr_b16 v[180:181], v191 offset:8192
    v_mfma_f32_16x16x32_bf16 v[212:215], v[92:95], v[160:163], v[212:215]
    s_waitcnt lgkmcnt(8)
    s_barrier
    s_cbranch_scc0 LG_v_xa5
LG_v_xb5:
    ds_read_b64_tr_b16 v[162:163], v184 offset:1024
    v_xor_b32 v191, 32, v184
    v_mfma_f32_16x16x32_bf16 v[216:219], v[88:91], v[164:167], v[216:219]
    ds_read_b64_tr_b16 v[160:161], v184 offset:0
    v_mfma_f32_16x16x32_bf16 v[220:223], v[92:95], v[164:167], v[220:223]
    s_waitcnt lgkmcnt(8)
    ds_read_b64_tr_b16 v[166:167], v191 offset:1024
    v_mfma_f32_16x16x32_bf16 v[224:227], v[88:91], v[168:171], v[224:227]
    ds_read_b64_tr_b16 v[164:165], v191 offset:0
    v_mfma_f32_16x16x32_bf16 v[228:231], v[92:95], v[168:171], v[228:231]
    s_waitcnt lgkmcnt(8)
    ds_read_b64_tr_b16 v[170:171], v185 offset:1024
    v_xor_b32 v191, 32, v185
    v_mfma_f32_16x16x32_bf16 v[232:235], v[88:91], v[172:175], v[232:235]
    ds_read_b64_tr_b16 v[168:169], v185 offset:0
    v_mfma_f32_16x16x32_bf16 v[236:239], v[92:95], v[172:175], v[236:239]
    s_waitcnt lgkmcnt(8)
    ds_read_b64_tr_b16 v[174:175], v191 offset:1024
    v_mfma_f32_16x16x32_bf16 v[240:243], v[88:91], v[176:179], v[240:243]
    ds_read_b64_tr_b16 v[172:173], v191 offset:0
    v_mfma_f32_16x16x32_bf16 v[244:247], v[92:95], v[176:179], v[244:247]
    s_waitcnt lgkmcnt(8)
    ds_read_b64_tr_b16 v[178:179], v186 offset:1024
    v_xor_b32 v191, 32, v186
    v_mfma_f32_16x16x32_bf16 v[248:251], v[88:91], v[180:183], v[248:251]
    ds_read_b64_tr_b16 v[176:177], v186 offset:0
    v_mfma_f32_16x16x32_bf16 v[252:255], v[92:95], v[180:183], v[252:255]
    s_waitcnt lgkmcnt(8)
    ds_read_b64_tr_b16 v[182:183], v191 offset:1024
    v_mfma_f32_16x16x32_bf16 v[192:195], v[96:99], v[160:163], v[192:195]
    s_cmp_eq_u32 s99, 1
    ds_read_b64_tr_b16 v[180:181], v191 offset:0
    v_mfma_f32_16x16x32_bf16 v[196:199], v[100:103], v[160:163], v[196:199]
    s_waitcnt lgkmcnt(8)
    ds_read_b64_tr_b16 v[162:163], v187 offset:1024
    v_xor_b32 v191, 32, v187
    v_mfma_f32_16x16x32_bf16 v[200:203], v[96:99], v[164:167], v[200:203]
    s_mov_b32 s55, 4294885376
    ds_read_b64_tr_b16 v[160:161], v187 offset:0
    v_mfma_f32_16x16x32_bf16 v[204:207], v[100:103], v[164:167], v[204:207]
    s_waitcnt lgkmcnt(8)
    ds_read_b64_tr_b16 v[166:167], v191 offset:1024
    v_mfma_f32_16x16x32_bf16 v[208:211], v[96:99], v[168:171], v[208:211]
    s_cmov_b32 s55, 16384
    ds_read_b64_tr_b16 v[164:165], v191 offset:0
    v_mfma_f32_16x16x32_bf16 v[212:215], v[100:103], v[168:171], v[212:215]
    s_waitcnt lgkmcnt(8)
    ds_read_b64_tr_b16 v[170:171], v184 offset:9216
    v_xor_b32 v191, 32, v184
    v_mfma_f32_16x16x32_bf16 v[216:219], v[96:99], v[172:175], v[216:219]
    ds_read_b64_tr_b16 v[168:169], v184 offset:8192
    v_mfma_f32_16x16x32_bf16 v[220:223], v[100:103], v[172:175], v[220:223]
    s_waitcnt lgkmcnt(8)
    ds_read_b64_tr_b16 v[174:175], v191 offset:9216
    v_add_u32 v184, s55, v184
    v_mfma_f32_16x16x32_bf16 v[224:227], v[96:99], v[176:179], v[224:227]
    ds_read_b64_tr_b16 v[172:173], v191 offset:8192
    v_mfma_f32_16x16x32_bf16 v[228:231], v[100:103], v[176:179], v[228:231]
    s_waitcnt lgkmcnt(8)
    ds_read_b64_tr_b16 v[178:179], v185 offset:9216
    v_xor_b32 v191, 32, v185
    v_mfma_f32_16x16x32_bf16 v[232:235], v[96:99], v[180:183], v[232:235]
    ds_read_b64_tr_b16 v[176:177], v185 offset:8192
    v_mfma_f32_16x16x32_bf16 v[236:239], v[100:103], v[180:183], v[236:239]
    s_waitcnt lgkmcnt(8)
    ds_read_b64_tr_b16 v[182:183], v191 offset:9216
    v_add_u32 v185, s55, v185
    v_mfma_f32_16x16x32_bf16 v[240:243], v[96:99], v[160:163], v[240:243]
    ds_read_b64_tr_b16 v[180:181], v191 offset:8192
    v_mfma_f32_16x16x32_bf16 v[244:247], v[100:103], v[160:163], v[244:247]
    s_waitcnt lgkmcnt(8)
    ds_read_b64_tr_b16 v[162:163], v186 offset:9216
    v_xor_b32 v191, 32, v186
    v_mfma_f32_16x16x32_bf16 v[248:251], v[96:99], v[164:167], v[248:251]
    ds_read_b64_tr_b16 v[160:161], v186 offset:8192
    v_mfma_f32_16x16x32_bf16 v[252:255], v[100:103], v[164:167], v[252:255]
    s_waitcnt lgkmcnt(8)
    ds_read_b64_tr_b16 v[166:167], v191 offset:9216
    v_add_u32 v186, s55, v186
    v_mfma_f32_16x16x32_bf16 v[192:195], v[104:107], v[168:171], v[192:195]
    ds_read_b64_tr_b16 v[164:165], v191 offset:8192
    v_mfma_f32_16x16x32_bf16 v[196:199], v[108:111], v[168:171], v[196:199]
    s_waitcnt lgkmcnt(8)
    ds_read_b64_tr_b16 v[170:171], v187 offset:9216
    v_xor_b32 v191, 32, v187
    v_mfma_f32_16x16x32_bf16 v[200:203], v[104:107], v[172:175], v[200:203]
    ds_read_b64_tr_b16 v[168:169], v187 offset:8192
    v_mfma_f32_16x16x32_bf16 v[204:207], v[108:111], v[172:175], v[204:207]
    s_waitcnt lgkmcnt(8)
    ds_read_b64_tr_b16 v[174:175], v191 offset:9216
    v_add_u32 v187, s55, v187
    v_mfma_f32_16x16x32_bf16 v[208:211], v[104:107], v[176:179], v[208:211]
    ds_read_b64_tr_b16 v[172:173], v191 offset:8192
    v_mfma_f32_16x16x32_bf16 v[212:215], v[108:111], v[176:179], v[212:215]
    s_waitcnt lgkmcnt(8)
    s_cbranch_scc0 LG_v_xa6
LG_v_xb6:
    ds_read_b64_tr_b16 v[178:179], v184 offset:1024
    v_xor_b32 v191, 32, v184
    v_mfma_f32_16x16x32_bf16 v[216:219], v[104:107], v[180:183], v[216:219]
    ds_read_b64_tr_b16 v[176:177], v184 offset:0
    v_mfma_f32_16x16x32_bf16 v[220:223], v[108:111], v[180:183], v[220:223]
    s_waitcnt lgkmcnt(8)
    ds_read_b64_tr_b16 v[182:183], v191 offset:1024
    v_mfma_f32_16x16x32_bf16 v[224:227], v[104:107], v[160:163], v[224:227]
    ds_read_b64_tr_b16 v[180:181], v191 offset:0
    v_mfma_f32_16x16x32_bf16 v[228:231], v[108:111], v[160:163], v[228:231]
    s_waitcnt lgkmcnt(8)
    ds_read_b64_tr_b16 v[162:163], v185 offset:1024
    v_xor_b32 v191, 32, v185
    v_mfma_f32_16x16x32_bf16 v[232:235], v[104:107], v[164:167], v[232:235]
    ds_read_b64_tr_b16 v[160:161], v185 offset:0
    v_mfma_f32_16x16x32_bf16 v[236:239], v[108:111], v[164:167], v[236:239]
    s_waitcnt lgkmcnt(8)
    ds_read_b64_tr_b16 v[166:167], v191 offset:1024
    v_mfma_f32_16x16x32_bf16 v[240:243], v[104:107], v[168:171], v[240:243]
    ds_read_b64_tr_b16 v[164:165], v191 offset:0
    v_mfma_f32_16x16x32_bf16 v[244:247], v[108:111], v[168:171], v[244:247]
    s_waitcnt lgkmcnt(8)
    ds_read_b64_tr_b16 v[170:171], v186 offset:1024
    v_xor_b32 v191, 32, v186
    v_mfma_f32_16x16x32_bf16 v[248:251], v[104:107], v[172:175], v[248:251]
    ds_read_b64_tr_b16 v[168:169], v186 offset:0
    v_mfma_f32_16x16x32_bf16 v[252:255], v[108:111], v[172:175], v[252:255]
    s_waitcnt lgkmcnt(8)
    ds_read_b64_tr_b16 v[174:175], v191 offset:1024
    v_mfma_f32_16x16x32_bf16 v[192:195], v[112:115], v[176:179], v[192:195]
    s_cmp_eq_u32 s99, 1
    ds_read_b64_tr_b16 v[172:173], v191 offset:0
    v_mfma_f32_16x16x32_bf16 v[196:199], v[116:119], v[176:179], v[196:199]
    s_waitcnt lgkmcnt(8)
    ds_read_b64_tr_b16 v[178:179], v187 offset:1024
    v_xor_b32 v191, 32, v187
    v_mfma_f32_16x16x32_bf16 v[200:203], v[112:115], v[180:183], v[200:203]
    s_mov_b32 s55, 32768
    ds_read_b64_tr_b16 v[176:177], v187 offset:0
    v_mfma_f32_16x16x32_bf16 v[204:207], v[116:119], v[180:183], v[204:207]
    s_waitcnt lgkmcnt(8)
    ds_read_b64_tr_b16 v[182:183], v191 offset:1024
    v_mfma_f32_16x16x32_bf16 v[208:211], v[112:115], v[160:163], v[208:211]
    s_cmov_b32 s55, 16384
    ds_read_b64_tr_b16 v[180:181], v191 offset:0
    v_mfma_f32_16x16x32_bf16 v[212:215], v[116:119], v[160:163], v[212:215]
    s_waitcnt lgkmcnt(8)
    ds_read_b64_tr_b16 v[162:163], v184 offset:9216
    v_xor_b32 v191, 32, v184
    v_mfma_f32_16x16x32_bf16 v[216:219], v[112:115], v[164:167], v[216:219]
    ds_read_b64_tr_b16 v[160:161], v184 offset:8192
    v_mfma_f32_16x16x32_bf16 v[220:223], v[116:119], v[164:167], v[220:223]
    s_waitcnt lgkmcnt(8)
    ds_read_b64_tr_b16 v[166:167], v191 offset:9216
    v_add_u32 v184, s55, v184
    v_mfma_f32_16x16x32_bf16 v[224:227], v[112:115], v[168:171], v[224:227]
    ds_read_b64_tr_b16 v[164:165], v191 offset:8192
    v_mfma_f32_16x16x32_bf16 v[228:231], v[116:119], v[168:171], v[228:231]
    s_waitcnt lgkmcnt(8)
    ds_read_b64_tr_b16 v[170:171], v185 offset:9216
    v_xor_b32 v191, 32, v185
    v_mfma_f32_16x16x32_bf16 v[232:235], v[112:115], v[172:175], v[232:235]
    ds_read_b64_tr_b16 v[168:169], v185 offset:8192
    v_mfma_f32_16x16x32_bf16 v[236:239], v[116:119], v[172:175], v[236:239]
    s_waitcnt lgkmcnt(8)
    ds_read_b64_tr_b16 v[174:175], v191 offset:9216
    v_add_u32 v185, s55, v185
    v_mfma_f32_16x16x32_bf16 v[240:243], v[112:115], v[176:179], v[240:243]
    ds_read_b64_tr_b16 v[172:173], v191 offset:8192
    v_mfma_f32_16x16x32_bf16 v[244:247], v[116:119], v[176:179], v[244:247]
    s_waitcnt lgkmcnt(8)
    ds_read_b64_tr_b16 v[178:179], v186 offset:9216
    v_xor_b32 v191, 32, v186
    v_mfma_f32_16x16x32_bf16 v[248:251], v[112:115], v[180:183], v[248:251]
    ds_read_b64_tr_b16 v[176:177], v186 offset:8192
    v_mfma_f32_16x16x32_bf16 v[252:255], v[116:119], v[180:183], v[252:255]
    s_waitcnt lgkmcnt(8)
    ds_read_b64_tr_b16 v[182:183], v191 offset:9216
    v_add_u32 v186, s55, v186
    v_mfma_f32_16x16x32_bf16 v[192:195], v[120:123], v[160:163], v[192:195]
    ds_read_b64_tr_b16 v[180:181], v191 offset:8192
    v_mfma_f32_16x16x32_bf16 v[196:199], v[124:127], v[160:163], v[196:199]
    s_waitcnt lgkmcnt(8)
    ds_read_b64_tr_b16 v[162:163], v187 offset:9216
    v_xor_b32 v191, 32, v187
    v_mfma_f32_16x16x32_bf16 v[200:203], v[120:123], v[164:167], v[200:203]
    ds_read_b64_tr_b16 v[160:161], v187 offset:8192
    v_mfma_f32_16x16x32_bf16 v[204:207], v[124:127], v[164:167], v[204:207]
    s_waitcnt lgkmcnt(8)
    ds_read_b64_tr_b16 v[166:167], v191 offset:9216
    v_add_u32 v187, s55, v187
    v_mfma_f32_16x16x32_bf16 v[208:211], v[120:123], v[168:171], v[208:211]
    ds_read_b64_tr_b16 v[164:165], v191 offset:8192
    v_mfma_f32_16x16x32_bf16 v[212:215], v[124:127], v[168:171], v[212:215]
    s_waitcnt lgkmcnt(8)
    s_cbranch_scc0 LG_v_xa7
LG_v_xb7:
    ds_read_b64_tr_b16 v[170:171], v184 offset:1024
    v_xor_b32 v191, 32, v184
    v_mfma_f32_16x16x32_bf16 v[216:219], v[120:123], v[172:175], v[216:219]
    ds_read_b64_tr_b16 v[168:169], v184 offset:0
    v_mfma_f32_16x16x32_bf16 v[220:223], v[124:127], v[172:175], v[220:223]
    s_waitcnt lgkmcnt(8)
    ds_read_b64_tr_b16 v[174:175], v191 offset:1024
    v_mfma_f32_16x16x32_bf16 v[224:227], v[120:123], v[176:179], v[224:227]
    ds_read_b64_tr_b16 v[172:173], v191 offset:0
    v_mfma_f32_16x16x32_bf16 v[228:231], v[124:127], v[176:179], v[228:231]
    s_waitcnt lgkmcnt(8)
    ds_read_b64_tr_b16 v[178:179], v185 offset:1024
    v_xor_b32 v191, 32, v185
    v_mfma_f32_16x16x32_bf16 v[232:235], v[120:123], v[180:183], v[232:235]
    ds_read_b64_tr_b16 v[176:177], v185 offset:0
    v_mfma_f32_16x16x32_bf16 v[236:239], v[124:127], v[180:183], v[236:239]
    s_waitcnt lgkmcnt(8)
    ds_read_b64_tr_b16 v[182:183], v191 offset:1024
    v_mfma_f32_16x16x32_bf16 v[240:243], v[120:123], v[160:163], v[240:243]
    ds_read_b64_tr_b16 v[180:181], v191 offset:0
    v_mfma_f32_16x16x32_bf16 v[244:247], v[124:127], v[160:163], v[244:247]
    s_waitcnt lgkmcnt(8)
    ds_read_b64_tr_b16 v[162:163], v186 offset:1024
    v_xor_b32 v191, 32, v186
    v_mfma_f32_16x16x32_bf16 v[248:251], v[120:123], v[164:167], v[248:251]
    ds_read_b64_tr_b16 v[160:161], v186 offset:0
    v_mfma_f32_16x16x32_bf16 v[252:255], v[124:127], v[164:167], v[252:255]
    s_waitcnt lgkmcnt(8)
    ds_read_b64_tr_b16 v[166:167], v191 offset:1024
    v_mfma_f32_16x16x32_bf16 v[192:195], v[128:131], v[168:171], v[192:195]
    s_cmp_eq_u32 s99, 1
    ds_read_b64_tr_b16 v[164:165], v191 offset:0
    v_mfma_f32_16x16x32_bf16 v[196:199], v[132:135], v[168:171], v[196:199]
    s_waitcnt lgkmcnt(8)
    ds_read_b64_tr_b16 v[170:171], v187 offset:1024
    v_xor_b32 v191, 32, v187
    v_mfma_f32_16x16x32_bf16 v[200:203], v[128:131], v[172:175], v[200:203]
    s_mov_b32 s55, 32768
    ds_read_b64_tr_b16 v[168:169], v187 offset:0
    v_mfma_f32_16x16x32_bf16 v[204:207], v[132:135], v[172:175], v[204:207]
    s_waitcnt lgkmcnt(8)
    ds_read_b64_tr_b16 v[174:175], v191 offset:1024
    v_mfma_f32_16x16x32_bf16 v[208:211], v[128:131], v[176:179], v[208:211]
    s_cmov_b32 s55, 16384
    ds_read_b64_tr_b16 v[172:173], v191 offset:0
    v_mfma_f32_16x16x32_bf16 v[212:215], v[132:135], v[176:179], v[212:215]
    s_waitcnt lgkmcnt(8)
    ds_read_b64_tr_b16 v[178:179], v184 offset:9216
    v_xor_b32 v191, 32, v184
    v_mfma_f32_16x16x32_bf16 v[216:219], v[128:131], v[180:183], v[216:219]
    ds_read_b64_tr_b16 v[176:177], v184 offset:8192
    v_mfma_f32_16x16x32_bf16 v[220:223], v[132:135], v[180:183], v[220:223]
    s_waitcnt lgkmcnt(8)
    ds_read_b64_tr_b16 v[182:183], v191 offset:9216
    v_add_u32 v184, s55, v184
    v_mfma_f32_16x16x32_bf16 v[224:227], v[128:131], v[160:163], v[224:227]
    ds_read_b64_tr_b16 v[180:181], v191 offset:8192
    v_mfma_f32_16x16x32_bf16 v[228:231], v[132:135], v[160:163], v[228:231]
    s_waitcnt lgkmcnt(8)
    ds_read_b64_tr_b16 v[162:163], v185 offset:9216
    v_xor_b32 v191, 32, v185
    v_mfma_f32_16x16x32_bf16 v[232:235], v[128:131], v[164:167], v[232:235]
    ds_read_b64_tr_b16 v[160:161], v185 offset:8192
    v_mfma_f32_16x16x32_bf16 v[236:239], v[132:135], v[164:167], v[236:239]
    s_waitcnt lgkmcnt(8)
    ds_read_b64_tr_b16 v[166:167], v191 offset:9216
    v_add_u32 v185, s55, v185
    v_mfma_f32_16x16x32_bf16 v[240:243], v[128:131], v[168:171], v[240:243]
    ds_read_b64_tr_b16 v[164:165], v191 offset:8192
    v_mfma_f32_16x16x32_bf16 v[244:247], v[132:135], v[168:171], v[244:247]
    s_waitcnt lgkmcnt(8)
    ds_read_b64_tr_b16 v[170:171], v186 offset:9216
    v_xor_b32 v191, 32, v186
    v_mfma_f32_16x16x32_bf16 v[248:251], v[128:131], v[172:175], v[248:251]
    ds_read_b64_tr_b16 v[168:169], v186 offset:8192
    v_mfma_f32_16x16x32_bf16 v[252:255], v[132:135], v[172:175], v[252:255]
    s_waitcnt lgkmcnt(8)
    ds_read_b64_tr_b16 v[174:175], v191 offset:9216
    v_add_u32 v186, s55, v186
    v_mfma_f32_16x16x32_bf16 v[192:195], v[136:139], v[176:179], v[192:195]
    ds_read_b64_tr_b16 v[172:173], v191 offset:8192
    v_mfma_f32_16x16x32_bf16 v[196:199], v[140:143], v[176:179], v[196:199]
    s_waitcnt lgkmcnt(8)
    ds_read_b64_tr_b16 v[178:179], v187 offset:9216
    v_xor_b32 v191, 32, v187
    v_mfma_f32_16x16x32_bf16 v[200:203], v[136:139], v[180:183], v[200:203]
    ds_read_b64_tr_b16 v[176:177], v187 offset:8192
    v_mfma_f32_16x16x32_bf16 v[204:207], v[140:143], v[180:183], v[204:207]
    s_waitcnt lgkmcnt(8)
    ds_read_b64_tr_b16 v[182:183], v191 offset:9216
    v_add_u32 v187, s55, v187
    v_mfma_f32_16x16x32_bf16 v[208:211], v[136:139], v[160:163], v[208:211]
    ds_read_b64_tr_b16 v[180:181], v191 offset:8192
    v_mfma_f32_16x16x32_bf16 v[212:215], v[140:143], v[160:163], v[212:215]
    s_waitcnt lgkmcnt(8)
    s_cbranch_scc0 LG_v_xa8
LG_v_xb8:
    ds_read_b64_tr_b16 v[162:163], v184 offset:1024
    v_mfma_f32_16x16x32_bf16 v[216:219], v[136:139], v[164:167], v[216:219]
    ds_read_b64_tr_b16 v[160:161], v184 offset:0
    v_mfma_f32_16x16x32_bf16 v[220:223], v[140:143], v[164:167], v[220:223]
    s_waitcnt lgkmcnt(8)
    ds_read_b64_tr_b16 v[166:167], v184 offset:9216
    v_xor_b32 v191, 32, v184
    v_mfma_f32_16x16x32_bf16 v[224:227], v[136:139], v[168:171], v[224:227]
    ds_read_b64_tr_b16 v[164:165], v184 offset:8192
    v_mfma_f32_16x16x32_bf16 v[228:231], v[140:143], v[168:171], v[228:231]
    s_waitcnt lgkmcnt(8)
    ds_read_b64_tr_b16 v[170:171], v191 offset:1024
    v_mfma_f32_16x16x32_bf16 v[232:235], v[136:139], v[172:175], v[232:235]
    ds_read_b64_tr_b16 v[168:169], v191 offset:0
    v_mfma_f32_16x16x32_bf16 v[236:239], v[140:143], v[172:175], v[236:239]
    s_waitcnt lgkmcnt(8)
    ds_read_b64_tr_b16 v[174:175], v191 offset:9216
    v_mfma_f32_16x16x32_bf16 v[240:243], v[136:139], v[176:179], v[240:243]
    ds_read_b64_tr_b16 v[172:173], v191 offset:8192
    v_mfma_f32_16x16x32_bf16 v[244:247], v[140:143], v[176:179], v[244:247]
    s_waitcnt lgkmcnt(8)
    ds_read_b64_tr_b16 v[178:179], v185 offset:1024
    v_mfma_f32_16x16x32_bf16 v[248:251], v[136:139], v[180:183], v[248:251]
    ds_read_b64_tr_b16 v[176:177], v185 offset:0
    v_mfma_f32_16x16x32_bf16 v[252:255], v[140:143], v[180:183], v[252:255]
    s_waitcnt lgkmcnt(8)
    ds_read_b64_tr_b16 v[182:183], v185 offset:9216
    v_xor_b32 v191, 32, v185
    v_mfma_f32_16x16x32_bf16 v[192:195], v[144:147], v[160:163], v[192:195]
    s_cmp_eq_u32 s99, 1
    s_setprio 2
    ds_read_b64_tr_b16 v[180:181], v185 offset:8192
    v_mfma_f32_16x16x32_bf16 v[196:199], v[148:151], v[160:163], v[196:199]
    s_waitcnt lgkmcnt(8)
    ds_read_b64_tr_b16 v[162:163], v191 offset:1024
    v_mfma_f32_16x16x32_bf16 v[192:195], v[152:155], v[164:167], v[192:195]
    s_mov_b32 s55, 49152
    ds_read_b64_tr_b16 v[160:161], v191 offset:0
    v_mfma_f32_16x16x32_bf16 v[196:199], v[156:159], v[164:167], v[196:199]
    s_waitcnt lgkmcnt(8)
    ds_read_b64_tr_b16 v[166:167], v191 offset:9216
    v_mfma_f32_16x16x32_bf16 v[200:203], v[144:147], v[168:171], v[200:203]
    ds_read_b64_tr_b16 v[164:165], v191 offset:8192
    v_mfma_f32_16x16x32_bf16 v[204:207], v[148:151], v[168:171], v[204:207]
    s_waitcnt lgkmcnt(8)
    ds_read_b64_tr_b16 v[170:171], v186 offset:1024
    v_mfma_f32_16x16x32_bf16 v[200:203], v[152:155], v[172:175], v[200:203]
    ds_read_b64_tr_b16 v[168:169], v186 offset:0
    v_mfma_f32_16x16x32_bf16 v[204:207], v[156:159], v[172:175], v[204:207]
    s_waitcnt lgkmcnt(8)
    ds_read_b64_tr_b16 v[174:175], v186 offset:9216
    v_xor_b32 v191, 32, v186
    v_mfma_f32_16x16x32_bf16 v[208:211], v[144:147], v[176:179], v[208:211]
    ds_read_b64_tr_b16 v[172:173], v186 offset:8192
    v_mfma_f32_16x16x32_bf16 v[212:215], v[148:151], v[176:179], v[212:215]
    s_waitcnt lgkmcnt(8)
    ds_read_b64_tr_b16 v[178:179], v191 offset:1024
    v_mfma_f32_16x16x32_bf16 v[208:211], v[152:155], v[180:183], v[208:211]
    ds_read_b64_tr_b16 v[176:177], v191 offset:0
    v_mfma_f32_16x16x32_bf16 v[212:215], v[156:159], v[180:183], v[212:215]
    s_waitcnt lgkmcnt(8)
    ds_read_b64_tr_b16 v[182:183], v191 offset:9216
    v_cvt_pk_bf16_f32 v192, v192, v193
    v_cvt_pk_bf16_f32 v193, v194, v195
    v_cvt_pk_bf16_f32 v194, v196, v197
    v_cvt_pk_bf16_f32 v195, v198, v199
    v_cvt_pk_bf16_f32 v196, v200, v201
    v_cvt_pk_bf16_f32 v197, v202, v203
    v_cvt_pk_bf16_f32 v198, v204, v205
    v_cvt_pk_bf16_f32 v199, v206, v207
    v_mfma_f32_16x16x32_bf16 v[216:219], v[144:147], v[160:163], v[216:219]
    ds_read_b64_tr_b16 v[180:181], v191 offset:8192
    v_mfma_f32_16x16x32_bf16 v[220:223], v[148:151], v[160:163], v[220:223]
    s_waitcnt lgkmcnt(8)
    ds_read_b64_tr_b16 v[162:163], v187 offset:1024
    buffer_store_dwordx4 v[192:195], v189, s[16:19], s56 offen offset:0 sc1
    buffer_store_dwordx4 v[196:199], v189, s[16:19], s56 offen offset:256 sc1
    v_add_u32 v184, s55, v184
    v_mfma_f32_16x16x32_bf16 v[216:219], v[152:155], v[164:167], v[216:219]
    ds_read_b64_tr_b16 v[160:161], v187 offset:0
    v_mfma_f32_16x16x32_bf16 v[220:223], v[156:159], v[164:167], v[220:223]
    s_waitcnt lgkmcnt(8)
    ds_read_b64_tr_b16 v[166:167], v187 offset:9216
    v_xor_b32 v191, 32, v187
    v_mfma_f32_16x16x32_bf16 v[224:227], v[144:147], v[168:171], v[224:227]
    ds_read_b64_tr_b16 v[164:165], v187 offset:8192
    v_mfma_f32_16x16x32_bf16 v[228:231], v[148:151], v[168:171], v[228:231]
    s_waitcnt lgkmcnt(8)
    ds_read_b64_tr_b16 v[170:171], v191 offset:1024
    v_add_u32 v185, s55, v185
    v_mfma_f32_16x16x32_bf16 v[224:227], v[152:155], v[172:175], v[224:227]
    ds_read_b64_tr_b16 v[168:169], v191 offset:0
    v_mfma_f32_16x16x32_bf16 v[228:231], v[156:159], v[172:175], v[228:231]
    s_waitcnt lgkmcnt(8)
    ds_read_b64_tr_b16 v[174:175], v191 offset:9216
    v_cvt_pk_bf16_f32 v200, v208, v209
    v_cvt_pk_bf16_f32 v201, v210, v211
    v_cvt_pk_bf16_f32 v202, v212, v213
    v_cvt_pk_bf16_f32 v203, v214, v215
    v_cvt_pk_bf16_f32 v204, v216, v217
    v_cvt_pk_bf16_f32 v205, v218, v219
    v_cvt_pk_bf16_f32 v206, v220, v221
    v_cvt_pk_bf16_f32 v207, v222, v223
    v_add_u32 v186, s55, v186
    v_mfma_f32_16x16x32_bf16 v[232:235], v[144:147], v[176:179], v[232:235]
    ds_read_b64_tr_b16 v[172:173], v191 offset:8192
    v_mfma_f32_16x16x32_bf16 v[236:239], v[148:151], v[176:179], v[236:239]
    s_waitcnt lgkmcnt(8)
    s_cbranch_scc0 LG_v_xa9
LG_v_xb9:
    buffer_store_dwordx4 v[200:203], v189, s[16:19], s56 offen offset:512 sc1
    buffer_store_dwordx4 v[204:207], v189, s[16:19], s56 offen offset:768 sc1
    v_add_u32 v187, s55, v187
    v_mfma_f32_16x16x32_bf16 v[232:235], v[152:155], v[180:183], v[232:235]
    v_mfma_f32_16x16x32_bf16 v[236:239], v[156:159], v[180:183], v[236:239]
    s_waitcnt lgkmcnt(6)
    s_cbranch_scc0 LG_v_np
    s_barrier
LG_v_np:
    v_mfma_f32_16x16x32_bf16 v[240:243], v[144:147], v[160:163], v[240:243]
    v_mfma_f32_16x16x32_bf16 v[244:247], v[148:151], v[160:163], v[244:247]
    s_waitcnt lgkmcnt(4)
    v_mfma_f32_16x16x32_bf16 v[240:243], v[152:155], v[164:167], v[240:243]
    v_mfma_f32_16x16x32_bf16 v[244:247], v[156:159], v[164:167], v[244:247]
    s_waitcnt lgkmcnt(2)
    s_nop 1
    v_cvt_pk_bf16_f32 v208, v224, v225
    v_cvt_pk_bf16_f32 v209, v226, v227
    v_cvt_pk_bf16_f32 v210, v228, v229
    v_cvt_pk_bf16_f32 v211, v230, v231
    v_cvt_pk_bf16_f32 v212, v232, v233
    v_cvt_pk_bf16_f32 v213, v234, v235
    v_cvt_pk_bf16_f32 v214, v236, v237
    v_cvt_pk_bf16_f32 v215, v238, v239
    v_mfma_f32_16x16x32_bf16 v[248:251], v[144:147], v[168:171], v[248:251]
    v_mfma_f32_16x16x32_bf16 v[252:255], v[148:151], v[168:171], v[252:255]
    s_waitcnt lgkmcnt(0)
    buffer_store_dwordx4 v[208:211], v189, s[16:19], s56 offen offset:1024 sc1
    buffer_store_dwordx4 v[212:215], v189, s[16:19], s56 offen offset:1280 sc1
    v_mfma_f32_16x16x32_bf16 v[248:251], v[152:155], v[172:175], v[248:251]
    v_mfma_f32_16x16x32_bf16 v[252:255], v[156:159], v[172:175], v[252:255]
    s_cbranch_scc1 LG_v_nopre
    ds_read_b64_tr_b16 v[162:163], v184 offset:1024
    ds_read_b64_tr_b16 v[160:161], v184 offset:0
    v_xor_b32 v191, 32, v184
    ds_read_b64_tr_b16 v[166:167], v191 offset:1024
    ds_read_b64_tr_b16 v[164:165], v191 offset:0
    ds_read_b64_tr_b16 v[170:171], v185 offset:1024
    ds_read_b64_tr_b16 v[168:169], v185 offset:0
    v_xor_b32 v191, 32, v185
    ds_read_b64_tr_b16 v[174:175], v191 offset:1024
    ds_read_b64_tr_b16 v[172:173], v191 offset:0
    ds_read_b64_tr_b16 v[178:179], v186 offset:1024
    ds_read_b64_tr_b16 v[176:177], v186 offset:0
    v_xor_b32 v191, 32, v186
    ds_read_b64_tr_b16 v[182:183], v191 offset:1024
LG_v_nopre:
    s_nop 6
    v_cvt_pk_bf16_f32 v216, v240, v241
    v_cvt_pk_bf16_f32 v217, v242, v243
    v_cvt_pk_bf16_f32 v218, v244, v245
    v_cvt_pk_bf16_f32 v219, v246, v247
    v_cvt_pk_bf16_f32 v220, v248, v249
    v_cvt_pk_bf16_f32 v221, v250, v251
    v_cvt_pk_bf16_f32 v222, v252, v253
    v_cvt_pk_bf16_f32 v223, v254, v255
    buffer_store_dwordx4 v[216:219], v189, s[16:19], s56 offen offset:1536 sc1
    buffer_store_dwordx4 v[220:223], v189, s[16:19], s56 offen offset:1792 sc1
    s_cbranch_scc1 LG_done
    s_mov_b32 s99, 1
    s_cmp_ge_u32 s45, 5
    s_cselect_b32 s47, 6, 5
    s_add_u32 s96, s96, s47
    s_add_u32 s97, s97, s47
    s_add_u32 s56, s56, 6144
    s_add_u32 s57, s57, 6144
    s_mov_b32 s36, 0
    s_cmp_eq_u32 s45, 7
    s_cbranch_scc1 LG_idle
    s_branch LG_v_body
LG_v_xa0:
    s_lshl_b32 s47, s41, 8
    s_add_u32 s47, s47, s2
    s_sub_u32 s47, s47, 240
    s_cmp_lt_u32 s47, 16
    s_cbranch_scc0 LG_v_cleared
    s_lshl_b32 s47, s47, 12
    s_add_u32 s47, s47, 22609920
    v_mbcnt_lo_u32_b32 v190, -1, 0
    v_lshlrev_b32 v190, 7, v190
    v_mov_b32 v191, 0
    s_mov_b32 exec_hi, 0
    buffer_store_dword v191, v190, s[16:19], s47 offen sc1
    s_mov_b64 exec, -1
LG_v_cleared:
    v_add_u32 v188, 32768, v188
    v_xor_b32 v24, 64, v188
    ds_read_b128 v[16:19], v188 offset:0
    ds_read_b128 v[20:23], v24 offset:1024
    ds_read_b128 v[28:31], v188 offset:1024
    ds_read_b128 v[24:27], v24 offset:0
    s_branch LG_v_xb0
LG_v_xa1:
    v_add_u32 v188, 4294918144, v188
    v_xor_b32 v40, 64, v188
    s_barrier
    ds_read_b128 v[32:35], v188 offset:0
    ds_read_b128 v[36:39], v40 offset:1024
    ds_read_b128 v[44:47], v188 offset:1024
    ds_read_b128 v[40:43], v40 offset:0
    s_branch LG_v_xb1
LG_v_xa2:
    v_add_u32 v188, 4294885376, v188
    v_xor_b32 v56, 64, v188
    s_barrier
    ds_read_b128 v[48:51], v188 offset:0
    ds_read_b128 v[52:55], v56 offset:1024
    ds_read_b128 v[60:63], v188 offset:1024
    ds_read_b128 v[56:59], v56 offset:0
    s_branch LG_v_xb2
LG_v_xa3:
    s_waitcnt vmcnt(0)
    s_lshl_b32 s47, s41, 8
    s_add_u32 s47, s47, s2
    s_sub_u32 s47, s47, 240
    s_cmp_lt_u32 s47, 16
    s_cbranch_scc0 LG_v_nocount
    s_lshl_b32 s47, s47, 4
    v_mov_b32 v190, 0
    v_mov_b32 v191, 1
    s_mov_b64 exec, 1
    buffer_atomic_add v191, v190, s[24:27], s47 offen offset:12 sc1
    s_mov_b64 exec, -1
LG_v_nocount:
    v_mov_b32 v190, 4
    v_add_u32 v188, 32768, v188
    v_xor_b32 v72, 64, v188
    s_barrier
    ds_read_b128 v[64:67], v188 offset:0
    ds_read_b128 v[68:71], v72 offset:1024
    ds_read_b128 v[76:79], v188 offset:1024
    ds_read_b128 v[72:75], v72 offset:0
    s_branch LG_v_xb3
LG_v_xa4:
    v_add_u32 v188, 65536, v188
    v_xor_b32 v88, 64, v188
    s_barrier
    ds_read_b128 v[80:83], v188 offset:0
    ds_read_b128 v[84:87], v88 offset:1024
    ds_read_b128 v[92:95], v188 offset:1024
    ds_read_b128 v[88:91], v88 offset:0
    s_branch LG_v_xb4
LG_v_xa5:
    v_add_u32 v188, 32768, v188
    v_xor_b32 v104, 64, v188
    ds_read_b128 v[96:99], v188 offset:0
    ds_read_b128 v[100:103], v104 offset:1024
    ds_read_b128 v[108:111], v188 offset:1024
    ds_read_b128 v[104:107], v104 offset:0
    s_branch LG_v_xb5
LG_v_xa6:
    v_add_u32 v188, 4294918144, v188
    v_xor_b32 v120, 64, v188
    s_barrier
    ds_read_b128 v[112:115], v188 offset:0
    ds_read_b128 v[116:119], v120 offset:1024
    ds_read_b128 v[124:127], v188 offset:1024
    ds_read_b128 v[120:123], v120 offset:0
    s_branch LG_v_xb6
LG_v_xa7:
    v_add_u32 v188, 4294885376, v188
    v_xor_b32 v136, 64, v188
    s_barrier
    ds_read_b128 v[128:131], v188 offset:0
    ds_read_b128 v[132:135], v136 offset:1024
    ds_read_b128 v[140:143], v188 offset:1024
    ds_read_b128 v[136:139], v136 offset:0
    s_branch LG_v_xb7
LG_v_xa8:
    v_add_u32 v188, 32768, v188
    v_xor_b32 v152, 64, v188
    s_barrier
    ds_read_b128 v[144:147], v188 offset:0
    ds_read_b128 v[148:151], v152 offset:1024
    ds_read_b128 v[156:159], v188 offset:1024
    ds_read_b128 v[152:155], v152 offset:0
    s_branch LG_v_xb8
LG_v_xa9:
    s_barrier
    s_branch LG_v_xb9
LG_v_da0:
    s_waitcnt vmcnt(0)
    s_mov_b64 exec, 1
    ds_add_u32 v190, v190 offset:32764
    s_mov_b64 exec, -1
    s_mov_b32 s36, 1
    s_branch LG_v_db0
LG_v_da1:
    s_waitcnt vmcnt(0)
    s_mov_b64 exec, 1
    ds_add_u32 v190, v190 offset:32764
    s_mov_b64 exec, -1
    s_mov_b32 s36, 1
    s_branch LG_v_db1
LG_v_da2:
    s_waitcnt vmcnt(0)
    s_mov_b64 exec, 1
    ds_add_u32 v190, v190 offset:32764
    s_mov_b64 exec, -1
    s_mov_b32 s36, 1
    s_branch LG_v_db2
LG_v_da3:
    s_waitcnt vmcnt(0)
    s_mov_b64 exec, 1
    ds_add_u32 v190, v190 offset:32764
    s_mov_b64 exec, -1
    s_mov_b32 s36, 1
    s_branch LG_v_db3
LG_v_da4:
    s_waitcnt vmcnt(0)
    s_mov_b64 exec, 1
    ds_add_u32 v190, v190 offset:32764
    s_mov_b64 exec, -1
    s_mov_b32 s36, 1
    s_branch LG_v_db4
LG_idle:
    s_waitcnt lgkmcnt(0)
    s_barrier
    s_waitcnt vmcnt(0)
    s_mov_b64 exec, 1
    ds_add_u32 v190, v190 offset:32764
    s_mov_b64 exec, -1
    s_mov_b32 s36, 1
    s_barrier
    s_barrier
LG_done:
    s_setprio 0
    v_mbcnt_lo_u32_b32 v0, -1, 0
    v_mbcnt_hi_u32_b32 v0, -1, v0
    s_and_b32 s47, s41, 1
    s_lshl_b32 s47, s47, 12
    s_add_u32 s47, s47, 81920
    v_lshlrev_b32 v15, 4, v0
    v_add_u32 v3, s47, v15
    ds_read_b128 v[44:47], v3
    ds_read_b128 v[176:179], v3 offset:1024
    ds_read_b64 v[180:181], v3 offset:2048
    v_lshlrev_b32 v185, 7, v0
    s_mul_i32 s58, s43, 5
    s_add_u32 s58, s58, 1
    s_lshr_b32 s58, s58, 1
    s_lshl_b32 s58, s58, 9
    s_and_b32 s47, s43, 1
    s_mov_b32 s48, 1024
    s_cselect_b32 s48, 4294966792, s48
    s_add_u32 s59, s58, s48
    s_min_u32 s47, s58, s59
    s_add_u32 s49, s58, 512
    s_max_u32 s48, s59, s49
    s_lshr_b32 s47, s47, 12
    s_lshr_b32 s48, s48, 12
    s_cmp_eq_u32 s47, s48
    s_cselect_b32 s3, 16, 32
    s_waitcnt lgkmcnt(0)
    v_and_b32 v3, 7, v0
    v_mul_u32_u24 v3, 640, v3
    v_add_u32 v3, 0, v3
    v_mov_b32 v16, 0x3f803f80
    v_mov_b32 v17, 0x3f803f80
    v_mov_b32 v18, 0x3f803f80
    v_mov_b32 v19, 0x3f803f80
    ds_write_b128 v3, v[16:19]
    s_mov_b32 s56, 3
    s_mov_b32 s57, 255
    s_mov_b32 s53, 5120
    s_mov_b32 s52, 5120
    v_pk_mov_b32 v[40:41], 0, 0
    v_pk_mov_b32 v[42:43], 0, 0
    v_pk_mov_b32 v[136:137], 0, 0
    v_pk_mov_b32 v[138:139], 0, 0
    v_pk_mov_b32 v[140:141], 0, 0
    v_pk_mov_b32 v[142:143], 0, 0
    v_mov_b32 v182, 0xbf803f80
    v_mov_b32 v183, 0
    v_mov_b32 v189, 0
    v_mfma_f32_32x32x4_2b_bf16 v[144:175], v[40:41], v[40:41], 0
    s_add_u32 s54, s53, 67584
    s_mov_b32 s55, 7
    v_mov_b32 v192, 0xdddddddd
    v_lshrrev_b32 v193, 1, v15
    v_xor_b32 v193, v193, v15
    v_and_b32 v193, 64, v193
    v_mul_u32_u24 v193, 3, v193
    v_xor_b32 v193, v193, v15
    v_add_u32 v1, s52, v193
    v_mad_u32_u24 v2, v45, s52, v44
    v_mov_b32 v246, 95232
    v_mov_b32 v247, 1
    v_mov_b32 v20, -1
    v_mov_b32 v21, -1
    v_mov_b32 v22, -1
    v_mov_b32 v23, -1
    s_setprio 2
    s_barrier
    s_waitcnt vmcnt(0)
    s_mov_b64 exec, 1
    ds_add_rtn_u32 v249, v246, v247
    s_mov_b64 exec, -1
    s_waitcnt lgkmcnt(0)
    v_readfirstlane_b32 s47, v249
    s_cmp_eq_u32 s47, 3
    s_cbranch_scc0 LG_nopub
    s_cmp_eq_u32 s45, 7
    s_cbranch_scc1 LG_nopub
    s_call_b64 s[62:63], LG_publish
LG_nopub:
    s_mov_b32 s47, 0
    s_mov_b32 s48, 2
    s_call_b64 s[62:63], LA_dma
    s_lshl_b32 s47, s44, 2
    s_add_u32 s47, s47, s41
    s_mul_i32 s37, s47, 81920
    s_add_u32 s37, s37, s98
    s_add_u32 s37, s37, 7864320
    s_lshr_b32 s48, s43, 3
    s_max_u32 s48, s48, 1
    s_sub_u32 s48, s48, 1
    s_lshl_b32 s97, s61, 5
    s_add_u32 s97, s97, s47
    s_mul_i32 s97, s97, 3
    s_add_u32 s97, s97, s48
    s_lshl_b32 s97, s97, 7
    s_add_u32 s97, s97, 22642688
    s_add_u32 s47, s37, s58
    s_add_u32 s48, s47, 40960
    s_add_u32 s49, s37, s59
    buffer_store_dwordx4 v[20:23], v15, s[16:19], s47 offen sc1
    buffer_store_dwordx4 v[20:23], v15, s[16:19], s48 offen sc1
    buffer_store_dwordx2 v[20:21], v46, s[16:19], s49 offen sc1
    s_mov_b32 s96, -1
    s_waitcnt vmcnt(0)
    s_barrier
    s_lshl_b32 s47, s61, 5
    s_add_u32 s47, s47, s43
    s_lshl_b32 s47, s47, 9
    s_add_u32 s47, s47, 22609920
    s_mov_b32 s60, 262144
    s_mov_b64 exec, 7
LF_pc2:
    v_mov_b32 v188, 0
    buffer_atomic_add v188, v185, s[16:19], s47 offen sc0 sc1
LF_pc2_w:
    s_waitcnt vmcnt(0)
    v_cmp_gt_u32 vcc, s3, v188
    s_cbranch_vccz LF_pc2_ok
    s_sleep 2
    s_sub_u32 s60, s60, 1
    s_cbranch_scc0 LF_pc2
LF_pc2_ok:
    s_mov_b64 exec, -1
    s_lshl_b32 s47, s44, 2
    s_add_u32 s47, s47, s41
    s_mul_i32 s47, s47, 81920
    s_add_u32 s47, s47, s98
    s_add_u32 s48, s47, s58
    s_add_u32 s49, s48, 40960
    s_add_u32 s47, s47, s59
    buffer_load_dwordx4 v[4:7], v15, s[16:19], s48 offen sc1
    buffer_load_dwordx4 v[8:11], v15, s[16:19], s49 offen sc1
    buffer_load_dwordx2 v[12:13], v46, s[16:19], s47 offen sc1
    s_mov_b32 s47, 1
    s_mov_b32 s48, 0
    s_call_b64 s[62:63], LA_dma
    s_mov_b32 s47, 0
    s_mov_b32 s48, 3
    s_call_b64 s[62:63], LA_dma
    s_waitcnt vmcnt(0) lgkmcnt(0)
    s_barrier
    s_mov_b32 s47, 1
    s_mov_b32 s48, 1
    s_call_b64 s[62:63], LA_dma
    s_mov_b32 s47, 0
    s_mov_b32 s48, 4
    s_call_b64 s[62:63], LA_dma
    s_mov_b32 s47, 1
    s_mov_b32 s48, 2
    s_call_b64 s[62:63], LA_dma
    s_mov_b32 s4, 0x3ea52b5c
    s_mov_b32 s5, s4
    s_waitcnt vmcnt(63)
    v_lshlrev_b32 v190, 16, v4
    v_and_b32 v191, 0xffff0000, v4
    v_pk_mul_f32 v[190:191], v[190:191], s[4:5]
    v_cvt_pk_bf16_f32 v4, v190, v191
    v_lshlrev_b32 v190, 16, v5
    v_and_b32 v191, 0xffff0000, v5
    v_pk_mul_f32 v[190:191], v[190:191], s[4:5]
    v_cvt_pk_bf16_f32 v5, v190, v191
    v_lshlrev_b32 v190, 16, v6
    v_and_b32 v191, 0xffff0000, v6
    v_pk_mul_f32 v[190:191], v[190:191], s[4:5]
    v_cvt_pk_bf16_f32 v6, v190, v191
    v_lshlrev_b32 v190, 16, v7
    v_and_b32 v191, 0xffff0000, v7
    v_pk_mul_f32 v[190:191], v[190:191], s[4:5]
    v_cvt_pk_bf16_f32 v7, v190, v191
    v_lshlrev_b32 v190, 16, v8
    v_and_b32 v191, 0xffff0000, v8
    v_pk_mul_f32 v[190:191], v[190:191], s[4:5]
    v_cvt_pk_bf16_f32 v8, v190, v191
    v_lshlrev_b32 v190, 16, v9
    v_and_b32 v191, 0xffff0000, v9
    v_pk_mul_f32 v[190:191], v[190:191], s[4:5]
    v_cvt_pk_bf16_f32 v9, v190, v191
    v_lshlrev_b32 v190, 16, v10
    v_and_b32 v191, 0xffff0000, v10
    v_pk_mul_f32 v[190:191], v[190:191], s[4:5]
    v_cvt_pk_bf16_f32 v10, v190, v191
    v_lshlrev_b32 v190, 16, v11
    v_and_b32 v191, 0xffff0000, v11
    v_pk_mul_f32 v[190:191], v[190:191], s[4:5]
    v_cvt_pk_bf16_f32 v11, v190, v191
    v_lshlrev_b32 v190, 16, v12
    v_and_b32 v191, 0xffff0000, v12
    v_pk_mul_f32 v[190:191], v[190:191], s[4:5]
    v_cvt_pk_bf16_f32 v12, v190, v191
    v_lshlrev_b32 v190, 16, v13
    v_and_b32 v191, 0xffff0000, v13
    v_pk_mul_f32 v[190:191], v[190:191], s[4:5]
    v_cvt_pk_bf16_f32 v13, v190, v191
    s_branch LA_start
LA_lead:
    s_setprio 3
    s_mov_b32 s60, 262144
    s_mov_b64 exec, 7
    v_mov_b32 v188, 0
    buffer_atomic_add v188, v185, s[16:19], s15 offen sc0 sc1
    s_mov_b64 exec, -1
    s_cmp_lt_u32 s41, 2
    s_cbranch_scc0 LA_sw1
    s_and_b32 s47, s41, 1
    s_lshl_b32 s47, s47, 12
    s_add_u32 s47, s47, 81920
    v_add_u32 v3, s47, v15
    v_mov_b32 v20, v248
    v_mov_b32 v21, v45
    v_mov_b32 v22, v46
    v_mov_b32 v23, v47
    ds_write_b128 v3, v[20:23]
    ds_write_b128 v3, v[176:179] offset:1024
    ds_write_b64 v3, v[180:181] offset:2048
    s_branch LA_sw2
LA_sw1:
    v_mov_b32 v184, 95232
    s_mov_b64 exec, 0xff
    ds_write_b32 v184, v183
    v_and_b32 v3, 7, v0
    v_mul_u32_u24 v3, 640, v3
    v_add_u32 v3, 90112, v3
    v_mov_b32 v16, 0x3f803f80
    v_mov_b32 v17, 0x3f803f80
    v_mov_b32 v18, 0x3f803f80
    v_mov_b32 v19, 0x3f803f80
    ds_write_b128 v3, v[16:19]
LA_sw2:
    s_mov_b64 exec, 7
    s_branch LF_pc3_w
LF_pc3:
    v_mov_b32 v188, 0
    buffer_atomic_add v188, v185, s[16:19], s15 offen sc0 sc1
LF_pc3_w:
    s_waitcnt vmcnt(0)
    v_cmp_gt_u32 vcc, s3, v188
    s_cbranch_vccz LF_pc3_ok
    s_sleep 2
    s_sub_u32 s60, s60, 1
    s_cbranch_scc0 LF_pc3
LF_pc3_ok:
    s_mov_b64 exec, -1
    buffer_load_dwordx4 v[4:7], v15, s[16:19], s8 offen sc1
    buffer_load_dwordx4 v[8:11], v15, s[16:19], s9 offen sc1
    buffer_load_dwordx2 v[12:13], v46, s[16:19], s10 offen sc1
    buffer_load_dwordx4 v176, s[16:19], s11 offen sc1 lds
    s_add_u32 m0, m0, 1024
    s_nop 0
    buffer_load_dwordx4 v177, s[16:19], s11 offen sc1 lds
    s_add_u32 m0, m0, 1024
    s_nop 0
    buffer_load_dwordx4 v178, s[16:19], s11 offen sc1 lds
    s_add_u32 m0, m0, 1024
    s_nop 0
    buffer_load_dwordx4 v179, s[16:19], s11 offen sc1 lds
    s_add_u32 m0, m0, 1024
    s_nop 0
    buffer_load_dwordx4 v180, s[16:19], s11 offen sc1 lds
    s_add_u32 m0, m0, 1024
    s_cmp_eq_u32 s14, 1
    s_cbranch_scc1 LA_ld0
    buffer_load_dwordx4 v181, s[16:19], s11 offen sc1 lds
LA_ld0:
    s_add_u32 m0, s13, 141312
    s_nop 0
    buffer_load_dwordx4 v176, s[16:19], s12 offen sc1 lds
    s_add_u32 m0, m0, 1024
    s_nop 0
    buffer_load_dwordx4 v177, s[16:19], s12 offen sc1 lds
    s_add_u32 m0, m0, 1024
    s_nop 0
    buffer_load_dwordx4 v178, s[16:19], s12 offen sc1 lds
    s_add_u32 m0, m0, 1024
    s_nop 0
    buffer_load_dwordx4 v179, s[16:19], s12 offen sc1 lds
    s_add_u32 m0, m0, 1024
    s_nop 0
    buffer_load_dwordx4 v180, s[16:19], s12 offen sc1 lds
    s_add_u32 m0, m0, 1024
    s_cmp_eq_u32 s14, 1
    s_cbranch_scc1 LA_ld1
    buffer_load_dwordx4 v181, s[16:19], s12 offen sc1 lds
LA_ld1:
    s_mov_b32 s4, 0x3ea52b5c
    s_mov_b32 s5, s4
    s_waitcnt vmcnt(10)
    v_lshlrev_b32 v190, 16, v4
    v_and_b32 v191, 0xffff0000, v4
    v_pk_mul_f32 v[190:191], v[190:191], s[4:5]
    v_cvt_pk_bf16_f32 v4, v190, v191
    v_lshlrev_b32 v190, 16, v5
    v_and_b32 v191, 0xffff0000, v5
    v_pk_mul_f32 v[190:191], v[190:191], s[4:5]
    v_cvt_pk_bf16_f32 v5, v190, v191
    v_lshlrev_b32 v190, 16, v6
    v_and_b32 v191, 0xffff0000, v6
    v_pk_mul_f32 v[190:191], v[190:191], s[4:5]
    v_cvt_pk_bf16_f32 v6, v190, v191
    v_lshlrev_b32 v190, 16, v7
    v_and_b32 v191, 0xffff0000, v7
    v_pk_mul_f32 v[190:191], v[190:191], s[4:5]
    v_cvt_pk_bf16_f32 v7, v190, v191
    v_lshlrev_b32 v190, 16, v8
    v_and_b32 v191, 0xffff0000, v8
    v_pk_mul_f32 v[190:191], v[190:191], s[4:5]
    v_cvt_pk_bf16_f32 v8, v190, v191
    v_lshlrev_b32 v190, 16, v9
    v_and_b32 v191, 0xffff0000, v9
    v_pk_mul_f32 v[190:191], v[190:191], s[4:5]
    v_cvt_pk_bf16_f32 v9, v190, v191
    v_lshlrev_b32 v190, 16, v10
    v_and_b32 v191, 0xffff0000, v10
    v_pk_mul_f32 v[190:191], v[190:191], s[4:5]
    v_cvt_pk_bf16_f32 v10, v190, v191
    v_lshlrev_b32 v190, 16, v11
    v_and_b32 v191, 0xffff0000, v11
    v_pk_mul_f32 v[190:191], v[190:191], s[4:5]
    v_cvt_pk_bf16_f32 v11, v190, v191
    v_lshlrev_b32 v190, 16, v12
    v_and_b32 v191, 0xffff0000, v12
    v_pk_mul_f32 v[190:191], v[190:191], s[4:5]
    v_cvt_pk_bf16_f32 v12, v190, v191
    v_lshlrev_b32 v190, 16, v13
    v_and_b32 v191, 0xffff0000, v13
    v_pk_mul_f32 v[190:191], v[190:191], s[4:5]
    v_cvt_pk_bf16_f32 v13, v190, v191
    s_waitcnt vmcnt(5) lgkmcnt(0)
    s_barrier
    s_setprio 1
LA_start:
    ds_read_b128 v[16:19], v1 offset:2048
    ds_read2st64_b64 v[24:27], v1 offset0:0 offset1:2
    ds_read_b128 v[20:23], v1 offset:3072
    ds_read_b128 v[28:31], v2
    ds_read_b128 v[32:35], v2 offset:640
    s_waitcnt lgkmcnt(4)
    v_mfma_f32_32x32x16_bf16 v[80:95], v[16:19], v[4:7], 0
    v_mfma_f32_32x32x16_bf16 v[96:111], v[16:19], v[8:11], 0
    s_nop 8
    s_waitcnt lgkmcnt(3)
    v_mfma_f32_32x32x4_2b_bf16 v[80:111], v[24:25], v[12:13], v[80:111] cbsz:1 abid:0
    s_nop 15
    s_nop 3
    v_max3_f32 v3, v80, v81, v82
    v_max3_f32 v3, v3, v83, v84
    v_max3_f32 v3, v3, v85, v86
    v_max3_f32 v3, v3, v87, v88
    v_max3_f32 v3, v3, v89, v90
    v_max3_f32 v3, v3, v91, v92
    v_max3_f32 v3, v3, v93, v94
    v_max_f32 v3, v3, v95
    v_max3_f32 v14, v96, v97, v98
    v_max3_f32 v14, v14, v99, v100
    v_max3_f32 v14, v14, v101, v102
    v_max3_f32 v14, v14, v103, v104
    v_max3_f32 v14, v14, v105, v106
    v_max3_f32 v14, v14, v107, v108
    v_max3_f32 v14, v14, v109, v110
    v_max_f32 v14, v14, v111
    s_nop 1
    v_permlane32_swap_b32 v3, v14
    s_nop 1
    v_max_f32 v3, v3, v14
    v_and_b32 v188, 0xffff0000, v3
    v_or_b32 v188, 0x3bb8, v188
    s_nop 1
    v_mfma_f32_32x32x4_2b_bf16 v[80:111], v[182:183], v[188:189], v[80:111]
    v_mfma_f32_32x32x4_2b_bf16 v[48:79], v[182:183], v[188:189], 0
    s_nop 15
    s_nop 0
    s_setprio 1
    s_waitcnt lgkmcnt(0)
.p2align 6
LA_loop:
    v_exp_f32 v80, v80
    v_exp_f32 v81, v81
    v_smfmac_f32_32x32x32_bf16 v[160:175], v[40:43], v[136:143], v192
    ds_read_b128 v[36:39], v2 offset:1280
    v_exp_f32 v82, v82
    v_exp_f32 v83, v83
    v_exp_f32 v84, v84
    v_exp_f32 v85, v85
    v_mfma_f32_32x32x4_2b_bf16 v[112:143], v[24:25], v[12:13], v[48:79] cbsz:1 abid:1
    v_exp_f32 v86, v86
    v_exp_f32 v87, v87
    v_exp_f32 v88, v88
    v_exp_f32 v89, v89
    v_exp_f32 v90, v90
    v_exp_f32 v91, v91
    v_exp_f32 v92, v92
    v_exp_f32 v93, v93
    v_smfmac_f32_32x32x32_bf16 v[144:159], v[28:31], v[80:87], v192
    ds_read_b128 v[40:43], v2 offset:1920
    v_exp_f32 v94, v94
    v_exp_f32 v95, v95
    v_exp_f32 v96, v96
    v_exp_f32 v97, v97
    v_smfmac_f32_32x32x32_bf16 v[144:159], v[32:35], v[88:95], v192
    ds_read_b128 v[16:19], v1 offset:4096
    v_exp_f32 v98, v98
    v_exp_f32 v99, v99
    v_exp_f32 v100, v100
    v_exp_f32 v101, v101
    v_mfma_f32_32x32x16_bf16 v[112:127], v[20:23], v[4:7], v[112:127]
    s_add_u32 s52, s52, 11264
    v_exp_f32 v102, v102
    v_exp_f32 v103, v103
    v_exp_f32 v104, v104
    v_exp_f32 v105, v105
    v_mfma_f32_32x32x16_bf16 v[128:143], v[20:23], v[8:11], v[128:143]
    v_exp_f32 v106, v106
    v_exp_f32 v107, v107
    v_exp_f32 v108, v108
    v_exp_f32 v109, v109
    v_smfmac_f32_32x32x32_bf16 v[160:175], v[28:31], v[96:103], v192
    s_waitcnt lgkmcnt(0)
    v_exp_f32 v110, v110
    v_exp_f32 v111, v111
    v_exp_f32 v112, v112
    v_exp_f32 v113, v113
    v_smfmac_f32_32x32x32_bf16 v[160:175], v[32:35], v[104:111], v192
    ds_read_b128 v[28:31], v2 offset:2560
    v_exp_f32 v114, v114
    v_exp_f32 v115, v115
    v_exp_f32 v116, v116
    v_exp_f32 v117, v117
    v_mfma_f32_32x32x4_2b_bf16 v[80:111], v[26:27], v[12:13], v[48:79] cbsz:1 abid:0
    v_exp_f32 v118, v118
    v_exp_f32 v119, v119
    v_exp_f32 v120, v120
    v_exp_f32 v121, v121
    v_exp_f32 v122, v122
    v_exp_f32 v123, v123
    v_exp_f32 v124, v124
    v_exp_f32 v125, v125
    v_smfmac_f32_32x32x32_bf16 v[144:159], v[36:39], v[112:119], v192
    ds_read_b128 v[32:35], v2 offset:3200
    v_exp_f32 v126, v126
    v_exp_f32 v127, v127
    v_exp_f32 v128, v128
    v_exp_f32 v129, v129
    v_smfmac_f32_32x32x32_bf16 v[144:159], v[40:43], v[120:127], v192
    ds_read_b128 v[20:23], v1 offset:5120
    v_exp_f32 v130, v130
    v_exp_f32 v131, v131
    v_exp_f32 v132, v132
    v_exp_f32 v133, v133
    v_mfma_f32_32x32x16_bf16 v[80:95], v[16:19], v[4:7], v[80:95]
    s_cmp_eq_u32 s56, s96
    v_exp_f32 v134, v134
    v_exp_f32 v135, v135
    v_exp_f32 v136, v136
    v_exp_f32 v137, v137
    v_mfma_f32_32x32x16_bf16 v[96:111], v[16:19], v[8:11], v[96:111]
    s_cbranch_scc1 LR_step
LA_bar:
    v_exp_f32 v138, v138
    v_exp_f32 v139, v139
    v_exp_f32 v140, v140
    v_exp_f32 v141, v141
    v_smfmac_f32_32x32x32_bf16 v[160:175], v[36:39], v[128:135], v192
    s_waitcnt lgkmcnt(0)
    v_exp_f32 v142, v142
    v_exp_f32 v143, v143
    v_exp_f32 v80, v80
    v_exp_f32 v81, v81
    v_smfmac_f32_32x32x32_bf16 v[160:175], v[40:43], v[136:143], v192
    ds_read_b128 v[36:39], v2 offset:3840
    v_exp_f32 v82, v82
    v_exp_f32 v83, v83
    v_exp_f32 v84, v84
    v_exp_f32 v85, v85
    v_mfma_f32_32x32x4_2b_bf16 v[112:143], v[26:27], v[12:13], v[48:79] cbsz:1 abid:1
    v_exp_f32 v86, v86
    v_exp_f32 v87, v87
    v_exp_f32 v88, v88
    v_exp_f32 v89, v89
    v_exp_f32 v90, v90
    v_exp_f32 v91, v91
    v_exp_f32 v92, v92
    v_exp_f32 v93, v93
    v_smfmac_f32_32x32x32_bf16 v[144:159], v[28:31], v[80:87], v192
    ds_read_b128 v[40:43], v2 offset:4480
    v_exp_f32 v94, v94
    v_exp_f32 v95, v95
    v_exp_f32 v96, v96
    v_exp_f32 v97, v97
    v_smfmac_f32_32x32x32_bf16 v[144:159], v[32:35], v[88:95], v192
    ds_read_b128 v[16:19], v1 offset:13312
    v_exp_f32 v98, v98
    v_exp_f32 v99, v99
    v_exp_f32 v100, v100
    v_exp_f32 v101, v101
    v_mfma_f32_32x32x16_bf16 v[112:127], v[20:23], v[4:7], v[112:127]
    ds_read2st64_b64 v[24:27], v1 offset0:22 offset1:24
    v_exp_f32 v102, v102
    v_exp_f32 v103, v103
    v_exp_f32 v104, v104
    v_exp_f32 v105, v105
    v_mfma_f32_32x32x16_bf16 v[128:143], v[20:23], v[8:11], v[128:143]
    s_setprio 0
    v_exp_f32 v106, v106
    v_exp_f32 v107, v107
    v_exp_f32 v108, v108
    v_exp_f32 v109, v109
    v_smfmac_f32_32x32x32_bf16 v[160:175], v[28:31], v[96:103], v192
    s_waitcnt lgkmcnt(0)
    v_exp_f32 v110, v110
    v_mad_u32_u24 v2, v45, s52, v44
    v_exp_f32 v111, v111
    v_exp_f32 v112, v112
    v_exp_f32 v113, v113
    v_smfmac_f32_32x32x32_bf16 v[160:175], v[32:35], v[104:111], v192
    ds_read_b128 v[28:31], v2 offset:0
    v_exp_f32 v114, v114
    v_exp_f32 v115, v115
    v_exp_f32 v116, v116
    v_exp_f32 v117, v117
    v_mfma_f32_32x32x4_2b_bf16 v[80:111], v[24:25], v[12:13], v[48:79] cbsz:1 abid:0
    v_exp_f32 v118, v118
    v_exp_f32 v119, v119
    v_exp_f32 v120, v120
    v_exp_f32 v121, v121
    v_exp_f32 v122, v122
    v_exp_f32 v123, v123
    v_exp_f32 v124, v124
    v_exp_f32 v125, v125
    v_smfmac_f32_32x32x32_bf16 v[144:159], v[36:39], v[112:119], v192
    ds_read_b128 v[32:35], v2 offset:640
    v_exp_f32 v126, v126
    v_exp_f32 v127, v127
    v_exp_f32 v128, v128
    v_exp_f32 v129, v129
    v_smfmac_f32_32x32x32_bf16 v[144:159], v[40:43], v[120:127], v192
    ds_read_b128 v[20:23], v1 offset:14336
    v_exp_f32 v130, v130
    v_exp_f32 v131, v131
    v_exp_f32 v132, v132
    v_exp_f32 v133, v133
    v_mfma_f32_32x32x16_bf16 v[80:95], v[16:19], v[4:7], v[80:95]
    s_bitcmp1_b32 s57, s56
    v_exp_f32 v134, v134
    v_exp_f32 v135, v135
    v_exp_f32 v136, v136
    v_exp_f32 v137, v137
    v_mfma_f32_32x32x16_bf16 v[96:111], v[16:19], v[8:11], v[96:111]
    v_exp_f32 v138, v138
    v_exp_f32 v139, v139
    v_exp_f32 v140, v140
    v_exp_f32 v141, v141
    v_smfmac_f32_32x32x32_bf16 v[160:175], v[36:39], v[128:135], v192
    s_waitcnt vmcnt(0) lgkmcnt(0)
    s_barrier
    s_setprio 1
    s_cbranch_scc1 LA_refill
LA_back:
    v_exp_f32 v142, v142
    v_exp_f32 v143, v143
    v_exp_f32 v80, v80
    v_exp_f32 v81, v81
    v_smfmac_f32_32x32x32_bf16 v[160:175], v[40:43], v[136:143], v192
    ds_read_b128 v[36:39], v2 offset:1280
    v_exp_f32 v82, v82
    v_exp_f32 v83, v83
    v_exp_f32 v84, v84
    v_exp_f32 v85, v85
    v_mfma_f32_32x32x4_2b_bf16 v[112:143], v[24:25], v[12:13], v[48:79] cbsz:1 abid:1
    v_exp_f32 v86, v86
    v_exp_f32 v87, v87
    v_exp_f32 v88, v88
    v_exp_f32 v89, v89
    v_exp_f32 v90, v90
    v_exp_f32 v91, v91
    v_exp_f32 v92, v92
    v_exp_f32 v93, v93
    v_smfmac_f32_32x32x32_bf16 v[144:159], v[28:31], v[80:87], v192
    ds_read_b128 v[40:43], v2 offset:1920
    v_exp_f32 v94, v94
    v_exp_f32 v95, v95
    v_exp_f32 v96, v96
    v_exp_f32 v97, v97
    v_smfmac_f32_32x32x32_bf16 v[144:159], v[32:35], v[88:95], v192
    ds_read_b128 v[16:19], v1 offset:15360
    v_exp_f32 v98, v98
    v_exp_f32 v99, v99
    v_exp_f32 v100, v100
    v_exp_f32 v101, v101
    v_mfma_f32_32x32x16_bf16 v[112:127], v[20:23], v[4:7], v[112:127]
    s_add_u32 s52, s52, 11264
    v_exp_f32 v102, v102
    v_exp_f32 v103, v103
    v_exp_f32 v104, v104
    v_exp_f32 v105, v105
    v_mfma_f32_32x32x16_bf16 v[128:143], v[20:23], v[8:11], v[128:143]
    s_cmp_eq_u32 s52, s54
    v_exp_f32 v106, v106
    v_exp_f32 v107, v107
    v_exp_f32 v108, v108
    v_exp_f32 v109, v109
    v_smfmac_f32_32x32x32_bf16 v[160:175], v[28:31], v[96:103], v192
    s_waitcnt lgkmcnt(0)
    v_exp_f32 v110, v110
    v_exp_f32 v111, v111
    v_exp_f32 v112, v112
    v_exp_f32 v113, v113
    v_smfmac_f32_32x32x32_bf16 v[160:175], v[32:35], v[104:111], v192
    ds_read_b128 v[28:31], v2 offset:2560
    v_exp_f32 v114, v114
    v_exp_f32 v115, v115
    v_exp_f32 v116, v116
    v_exp_f32 v117, v117
    v_mfma_f32_32x32x4_2b_bf16 v[80:111], v[26:27], v[12:13], v[48:79] cbsz:1 abid:0
    v_exp_f32 v118, v118
    v_exp_f32 v119, v119
    v_exp_f32 v120, v120
    v_exp_f32 v121, v121
    v_exp_f32 v122, v122
    v_exp_f32 v123, v123
    v_exp_f32 v124, v124
    v_exp_f32 v125, v125
    v_smfmac_f32_32x32x32_bf16 v[144:159], v[36:39], v[112:119], v192
    ds_read_b128 v[32:35], v2 offset:3200
    v_exp_f32 v126, v126
    v_exp_f32 v127, v127
    v_exp_f32 v128, v128
    v_exp_f32 v129, v129
    v_smfmac_f32_32x32x32_bf16 v[144:159], v[40:43], v[120:127], v192
    ds_read_b128 v[20:23], v1 offset:16384
    v_exp_f32 v130, v130
    v_exp_f32 v131, v131
    v_exp_f32 v132, v132
    v_exp_f32 v133, v133
    v_mfma_f32_32x32x16_bf16 v[80:95], v[16:19], v[4:7], v[80:95]
    s_cselect_b32 s52, s53, s52
    v_exp_f32 v134, v134
    v_exp_f32 v135, v135
    v_exp_f32 v136, v136
    v_exp_f32 v137, v137
    v_mfma_f32_32x32x16_bf16 v[96:111], v[16:19], v[8:11], v[96:111]
    s_add_u32 s56, s56, 1
    v_exp_f32 v138, v138
    v_exp_f32 v139, v139
    v_exp_f32 v140, v140
    v_exp_f32 v141, v141
    v_smfmac_f32_32x32x32_bf16 v[160:175], v[36:39], v[128:135], v192
    s_waitcnt lgkmcnt(0)
    v_exp_f32 v142, v142
    v_add_u32 v1, s52, v193
    v_exp_f32 v143, v143
    v_exp_f32 v80, v80
    v_exp_f32 v81, v81
    v_smfmac_f32_32x32x32_bf16 v[160:175], v[40:43], v[136:143], v192
    ds_read_b128 v[36:39], v2 offset:3840
    v_exp_f32 v82, v82
    v_exp_f32 v83, v83
    v_exp_f32 v84, v84
    v_exp_f32 v85, v85
    v_mfma_f32_32x32x4_2b_bf16 v[112:143], v[26:27], v[12:13], v[48:79] cbsz:1 abid:1
    v_exp_f32 v86, v86
    v_exp_f32 v87, v87
    v_exp_f32 v88, v88
    v_exp_f32 v89, v89
    v_exp_f32 v90, v90
    v_exp_f32 v91, v91
    v_exp_f32 v92, v92
    v_exp_f32 v93, v93
    v_smfmac_f32_32x32x32_bf16 v[144:159], v[28:31], v[80:87], v192
    ds_read_b128 v[40:43], v2 offset:4480
    v_exp_f32 v94, v94
    v_exp_f32 v95, v95
    v_exp_f32 v96, v96
    v_exp_f32 v97, v97
    v_smfmac_f32_32x32x32_bf16 v[144:159], v[32:35], v[88:95], v192
    ds_read_b128 v[16:19], v1 offset:2048
    v_exp_f32 v98, v98
    v_exp_f32 v99, v99
    v_exp_f32 v100, v100
    v_exp_f32 v101, v101
    v_mfma_f32_32x32x16_bf16 v[112:127], v[20:23], v[4:7], v[112:127]
    ds_read2st64_b64 v[24:27], v1 offset0:0 offset1:2
    v_exp_f32 v102, v102
    v_exp_f32 v103, v103
    v_exp_f32 v104, v104
    v_exp_f32 v105, v105
    v_mfma_f32_32x32x16_bf16 v[128:143], v[20:23], v[8:11], v[128:143]
    v_exp_f32 v106, v106
    v_exp_f32 v107, v107
    v_exp_f32 v108, v108
    v_exp_f32 v109, v109
    v_smfmac_f32_32x32x32_bf16 v[160:175], v[28:31], v[96:103], v192
    s_waitcnt lgkmcnt(0)
    v_exp_f32 v110, v110
    v_mad_u32_u24 v2, v45, s52, v44
    v_exp_f32 v111, v111
    v_exp_f32 v112, v112
    v_exp_f32 v113, v113
    v_smfmac_f32_32x32x32_bf16 v[160:175], v[32:35], v[104:111], v192
    ds_read_b128 v[28:31], v2 offset:0
    v_exp_f32 v114, v114
    v_exp_f32 v115, v115
    v_exp_f32 v116, v116
    v_exp_f32 v117, v117
    v_mfma_f32_32x32x4_2b_bf16 v[80:111], v[24:25], v[12:13], v[48:79] cbsz:1 abid:0
    v_exp_f32 v118, v118
    v_exp_f32 v119, v119
    v_exp_f32 v120, v120
    v_exp_f32 v121, v121
    v_exp_f32 v122, v122
    v_exp_f32 v123, v123
    v_exp_f32 v124, v124
    v_exp_f32 v125, v125
    v_smfmac_f32_32x32x32_bf16 v[144:159], v[36:39], v[112:119], v192
    ds_read_b128 v[32:35], v2 offset:640
    v_exp_f32 v126, v126
    v_exp_f32 v127, v127
    v_exp_f32 v128, v128
    v_exp_f32 v129, v129
    v_smfmac_f32_32x32x32_bf16 v[144:159], v[40:43], v[120:127], v192
    ds_read_b128 v[20:23], v1 offset:3072
    v_exp_f32 v130, v130
    v_exp_f32 v131, v131
    v_exp_f32 v132, v132
    v_exp_f32 v133, v133
    v_mfma_f32_32x32x16_bf16 v[80:95], v[16:19], v[4:7], v[80:95]
    v_exp_f32 v134, v134
    v_exp_f32 v135, v135
    v_exp_f32 v136, v136
    v_exp_f32 v137, v137
    v_mfma_f32_32x32x16_bf16 v[96:111], v[16:19], v[8:11], v[96:111]
    s_sub_u32 s55, s55, 1
    v_exp_f32 v138, v138
    v_exp_f32 v139, v139
    v_exp_f32 v140, v140
    v_exp_f32 v141, v141
    v_smfmac_f32_32x32x32_bf16 v[160:175], v[36:39], v[128:135], v192
    s_waitcnt lgkmcnt(0)
    v_exp_f32 v142, v142
    v_exp_f32 v143, v143
    s_cbranch_scc0 LA_loop
    s_nop 0
    v_smfmac_f32_32x32x32_bf16 v[160:175], v[40:43], v[136:143], v192
    s_cmp_eq_u32 s42, 0
    s_cbranch_scc1 LA_fin2
    s_setprio 2
    v_mov_b32 v182, 0
    v_mov_b32 v183, 1
    s_mov_b64 exec, 1
    buffer_atomic_add v183, v182, s[16:19], s97 offen sc1
    s_mov_b64 exec, -1
LA_fin2:
    s_mov_b32 s55, 0
LA_epi:
    v_cmp_lt_u32 vcc, 31, v0
    s_add_u32 s47, s37, s58
    s_add_u32 s48, s47, 40960
    v_cndmask_b32 v3, v156, v152, vcc
    v_rcp_f32 v112, v3
    v_pk_add_f32 v[116:117], v[144:145], v[146:147]
    v_pk_add_f32 v[116:117], v[116:117], v[148:149]
    v_pk_add_f32 v[116:117], v[116:117], v[150:151]
    v_pk_add_f32 v[116:117], v[116:117], v[152:153]
    v_pk_add_f32 v[116:117], v[116:117], v[154:155]
    v_pk_mul_f32 v[80:81], v[144:145], v[112:113] op_sel_hi:[1,0]
    v_pk_mul_f32 v[82:83], v[146:147], v[112:113] op_sel_hi:[1,0]
    v_pk_mul_f32 v[84:85], v[148:149], v[112:113] op_sel_hi:[1,0]
    v_pk_mul_f32 v[86:87], v[150:151], v[112:113] op_sel_hi:[1,0]
    v_pk_mul_f32 v[88:89], v[152:153], v[112:113] op_sel_hi:[1,0]
    v_pk_mul_f32 v[90:91], v[154:155], v[112:113] op_sel_hi:[1,0]
    v_cvt_pk_bf16_f32 v80, v80, v81
    v_cvt_pk_bf16_f32 v81, v82, v83
    v_cvt_pk_bf16_f32 v82, v84, v85
    v_cvt_pk_bf16_f32 v83, v86, v87
    v_cvt_pk_bf16_f32 v84, v88, v89
    v_cvt_pk_bf16_f32 v85, v90, v91
    v_cndmask_b32 v14, v172, v168, vcc
    v_rcp_f32 v114, v14
    v_pk_add_f32 v[116:117], v[116:117], v[160:161]
    v_pk_add_f32 v[116:117], v[116:117], v[162:163]
    v_pk_add_f32 v[116:117], v[116:117], v[164:165]
    v_pk_add_f32 v[116:117], v[116:117], v[166:167]
    v_pk_add_f32 v[116:117], v[116:117], v[168:169]
    v_pk_add_f32 v[116:117], v[116:117], v[170:171]
    v_add_f32 v116, v116, v117
    v_add_f32 v117, v3, v14
    v_fma_f32 v116, 0, v116, v117
    v_min_f32 v117, v3, v14
    v_cmp_gt_f32 vcc, 0x4e800000, v116
    s_mov_b64 s[4:5], vcc
    v_cmp_lt_f32 vcc, 0x30800000, v117
    v_min_u32 v80, -2, v80
    v_min_u32 v81, -2, v81
    v_min_u32 v82, -2, v82
    v_min_u32 v83, -2, v83
    s_and_b64 s[4:5], s[4:5], vcc
    s_cmp_eq_u64 s[4:5], -1
    s_cselect_b32 s50, 1, s55
    s_cmp_eq_u32 s50, 0
    s_cbranch_scc1 LA_slow
    buffer_store_dwordx4 v[80:83], v15, s[16:19], s47 offen sc1
    v_pk_mul_f32 v[92:93], v[160:161], v[114:115] op_sel_hi:[1,0]
    v_pk_mul_f32 v[94:95], v[162:163], v[114:115] op_sel_hi:[1,0]
    v_pk_mul_f32 v[96:97], v[164:165], v[114:115] op_sel_hi:[1,0]
    v_pk_mul_f32 v[98:99], v[166:167], v[114:115] op_sel_hi:[1,0]
    v_pk_mul_f32 v[100:101], v[168:169], v[114:115] op_sel_hi:[1,0]
    v_pk_mul_f32 v[102:103], v[170:171], v[114:115] op_sel_hi:[1,0]
    v_cvt_pk_bf16_f32 v92, v92, v93
    v_cvt_pk_bf16_f32 v93, v94, v95
    v_cvt_pk_bf16_f32 v94, v96, v97
    v_cvt_pk_bf16_f32 v95, v98, v99
    v_cvt_pk_bf16_f32 v96, v100, v101
    v_cvt_pk_bf16_f32 v97, v102, v103
    v_min_u32 v92, -2, v92
    v_min_u32 v93, -2, v93
    v_min_u32 v94, -2, v94
    v_min_u32 v95, -2, v95
    buffer_store_dwordx4 v[92:95], v15, s[16:19], s48 offen sc1
    v_permlane32_swap_b32 v84, v96
    v_permlane32_swap_b32 v85, v97
    s_add_u32 s49, s37, s59
    v_min_u32 v84, -2, v84
    v_min_u32 v85, -2, v85
    buffer_store_dwordx2 v[84:85], v46, s[16:19], s49 offen sc1
    s_cmp_eq_u32 s42, 0
    s_cbranch_scc1 LP_a
    s_barrier
    s_branch LP_end
LP_a:
    s_and_b32 s51, s43, 3
    s_lshl_b32 s48, s61, 2
    s_add_u32 s51, s51, s48
    s_lshl_b32 s51, s51, 7
    s_add_u32 s51, s51, 22667264
    s_mov_b32 s60, 262144
    s_mov_b64 exec, 1
    v_mov_b32 v188, 0
    buffer_atomic_add v188, v186, s[16:19], s51 offen sc0 sc1
    s_mov_b64 exec, -1
    v_pk_mov_b32 v[128:129], 0, 0
    v_pk_mov_b32 v[130:131], 0, 0
    v_pk_mov_b32 v[132:133], 0, 0
    v_pk_mov_b32 v[134:135], 0, 0
    v_pk_mov_b32 v[228:229], 0, 0
    v_pk_mov_b32 v[230:231], 0, 0
    v_pk_mov_b32 v[232:233], 0, 0
    v_pk_mov_b32 v[234:235], 0, 0
    v_mfma_f32_32x32x4_2b_bf16 v[96:127], v[128:129], v[128:129], 0
    v_mfma_f32_32x32x4_2b_bf16 v[196:227], v[128:129], v[128:129], 0
    s_lshl_b32 s48, s44, 2
    s_lshr_b32 s49, s43, 2
    s_add_u32 s48, s48, s49
    s_lshl_b32 s39, s61, 5
    s_add_u32 s39, s39, s48
    s_mul_i32 s39, s39, 3
    s_add_u32 s39, s39, s42
    s_lshl_b32 s39, s39, 7
    s_add_u32 s39, s39, 22642688
    v_and_b32 v185, 15, v0
    s_lshl_b32 s48, s48, 1
    s_lshr_b32 s49, s41, 1
    s_add_u32 s48, s48, s49
    s_mul_i32 s48, s48, 40960
    s_add_u32 s48, s48, s98
    s_and_b32 s49, s41, 1
    s_lshl_b32 s49, s49, 8
    s_add_u32 s48, s48, s49
    s_add_u32 s38, s48, 7864320
    v_lshrrev_b32 v3, 4, v0
    v_lshlrev_b32 v3, 9, v3
    v_lshl_add_u32 v3, v185, 4, v3
    v_lshlrev_b32 v187, 7, v0
    s_mov_b32 s54, s38
    s_add_u32 s55, s38, 10240
    s_lshl_b32 s47, s44, 2
    s_lshr_b32 s48, s43, 2
    s_add_u32 s47, s47, s48
    s_lshl_b32 s47, s47, 2
    s_add_u32 s47, s47, s41
    s_mul_i32 s47, s47, 40960
    s_mul_i32 s48, s61, 1280
    s_add_u32 s47, s47, s48
    s_and_b32 s48, s43, 3
    s_mul_i32 s48, s48, 320
    s_add_u32 s56, s47, s48
    s_add_u32 s57, s56, 5120
    v_lshrrev_b32 v4, 4, v0
    v_mul_u32_u24 v4, 10240, v4
    v_and_b32 v6, 15, v0
    s_and_b32 s47, s43, 1
    s_cselect_b32 s47, 64, 0
    s_cselect_b32 s48, 0, 256
    v_lshl_add_u32 v5, v6, 2, v4
    v_lshl_add_u32 v4, v6, 4, v4
    v_add_u32 v4, s47, v4
    v_add_u32 v5, s48, v5
    s_waitcnt vmcnt(0)
    v_mov_b32 v182, 0
    v_mov_b32 v183, 1
    s_mov_b64 exec, 1
    buffer_atomic_add v183, v182, s[16:19], s97 offen sc1
    s_mov_b64 exec, -1
    v_readfirstlane_b32 s47, v188
    s_cmp_ge_u32 s47, 16
    s_cbranch_scc1 LP_wo
    s_mov_b64 exec, 1
    s_branch LF_pc4_w
LF_pc4:
    v_mov_b32 v188, 0
    buffer_atomic_add v188, v186, s[16:19], s51 offen sc0 sc1
LF_pc4_w:
    s_waitcnt vmcnt(0)
    v_cmp_gt_u32 vcc, 16, v188
    s_cbranch_vccz LF_pc4_ok
    s_sleep 2
    s_sub_u32 s60, s60, 1
    s_cbranch_scc0 LF_pc4
LF_pc4_ok:
    s_mov_b64 exec, -1
LP_wo:
    s_setprio 0
    s_barrier
    s_mov_b32 s47, 1
    s_mov_b32 s48, 7
    s_call_b64 s[62:63], LA_dma
    s_and_b32 s47, s43, 3
    s_lshl_b32 s48, s61, 2
    s_add_u32 s47, s47, s48
    s_mul_i32 s47, s47, 204800
    s_lshl_b32 s48, s41, 10
    s_add_u32 s47, s47, s48
    s_add_u32 s47, s47, 20971520
    s_add_u32 s48, s48, 81920
LP_wd5:
    s_mov_b32 m0, s48
    s_add_u32 s48, s48, 4096
    buffer_load_dwordx4 v15, s[16:19], s47 offen sc1 lds
    s_add_u32 s47, s47, 4096
    s_cmp_lt_u32 s48, 112640
    s_cbranch_scc1 LP_wd5
    v_mov_b32 v190, 0
    s_mov_b64 exec, 1
    buffer_atomic_add v190, v187, s[16:19], s39 offen sc0 sc1
    s_mov_b64 exec, -1
    s_and_b32 s47, s43, 3
    s_lshl_b32 s48, s61, 2
    s_add_u32 s47, s47, s48
    s_mul_i32 s47, s47, 204800
    s_lshl_b32 s48, s41, 10
    s_add_u32 s47, s47, s48
    s_add_u32 s47, s47, 21002240
    s_add_u32 s48, s48, 112640
LP_wd6:
    s_mov_b32 m0, s48
    s_add_u32 s48, s48, 4096
    buffer_load_dwordx4 v15, s[16:19], s47 offen sc1 lds
    s_add_u32 s47, s47, 4096
    s_cmp_lt_u32 s48, 143360
    s_cbranch_scc1 LP_wd6
    s_waitcnt vmcnt(0)
    v_readfirstlane_b32 s47, v190
    s_cmp_ge_u32 s47, 16
    s_cbranch_scc1 LP_seen
    s_mov_b32 s60, 262144
    s_mov_b64 exec, 1
LF_pc7:
    v_mov_b32 v188, 0
    buffer_atomic_add v188, v186, s[16:19], s39 offen sc0 sc1
LF_pc7_w:
    s_waitcnt vmcnt(0)
    v_cmp_gt_u32 vcc, 16, v188
    s_cbranch_vccz LF_pc7_ok
    s_sleep 2
    s_sub_u32 s60, s60, 1
    s_cbranch_scc0 LF_pc7
LF_pc7_ok:
    s_mov_b64 exec, -1
LP_seen:
    s_call_b64 s[62:63], LP_ldhi
    s_call_b64 s[62:63], LP_ldlo
    s_add_u32 s38, s38, 20480
    s_add_u32 s39, s39, 128
    s_barrier
    s_mov_b32 s8, 81920
    s_mov_b32 s9, 92160
    s_mov_b32 s10, 102400
    s_mov_b32 s11, 112640
    s_mov_b32 s12, 122880
    s_mov_b32 s13, 133120
    s_mov_b32 s14, 143360
    s_mov_b32 s15, 153600
    s_mov_b32 s52, 51200
    s_mov_b32 s53, 61440
    s_call_b64 s[6:7], LP_pro
    s_waitcnt vmcnt(0)
    s_and_b32 s47, s43, 3
    s_lshl_b32 s48, s61, 2
    s_add_u32 s47, s47, s48
    s_mul_i32 s47, s47, 204800
    s_lshl_b32 s48, s41, 10
    s_add_u32 s47, s47, s48
    s_add_u32 s47, s47, 21032960
    s_add_u32 s48, s48, 143360
LP_wd8:
    s_mov_b32 m0, s48
    s_add_u32 s48, s48, 4096
    buffer_load_dwordx4 v15, s[16:19], s47 offen sc1 lds
    s_add_u32 s47, s47, 4096
    s_cmp_lt_u32 s48, 163840
    s_cbranch_scc1 LP_wd8
    s_and_b32 s47, s43, 3
    s_lshl_b32 s48, s61, 2
    s_add_u32 s47, s47, s48
    s_mul_i32 s47, s47, 204800
    s_lshl_b32 s48, s41, 10
    s_add_u32 s47, s47, s48
    s_add_u32 s47, s47, 21053440
    s_add_u32 s48, s48, 51200
LP_wd9:
    s_mov_b32 m0, s48
    s_add_u32 s48, s48, 4096
    buffer_load_dwordx4 v15, s[16:19], s47 offen sc1 lds
    s_add_u32 s47, s47, 4096
    s_cmp_lt_u32 s48, 81920
    s_cbranch_scc1 LP_wd9
    s_cmp_eq_u32 0, 1
    s_call_b64 s[6:7], LP_hi
    s_and_b32 s47, s43, 3
    s_lshl_b32 s48, s61, 2
    s_add_u32 s47, s47, s48
    s_mul_i32 s47, s47, 204800
    s_add_u32 s47, s47, 21084160
    s_waitcnt vmcnt(0) lgkmcnt(0)
    s_barrier
    s_setprio 1
    s_cmp_eq_u32 0, 0
    s_call_b64 s[6:7], LP_lo
    s_waitcnt vmcnt(4)
    v_cmp_le_u32 vcc, 8, v190
    s_and_b32 s99, vcc_lo, 3
    s_cbranch_scc0 LP_n1
    s_call_b64 s[62:63], LP_order
    s_waitcnt vmcnt(5)
    s_barrier
    s_branch LP_n2
LP_n1:
    s_waitcnt vmcnt(0)
    s_barrier
    s_mov_b32 s60, 262144
LP_any:
    v_mov_b32 v190, 0
    s_mov_b64 exec, 3
    buffer_atomic_add v190, v187, s[16:19], s39 offen sc0 sc1
    s_mov_b64 exec, -1
    s_waitcnt vmcnt(0)
    v_cmp_le_u32 vcc, 8, v190
    s_and_b32 s99, vcc_lo, 3
    s_cbranch_scc1 LP_got
    s_sleep 2
    s_sub_u32 s60, s60, 1
    s_cbranch_scc0 LP_any
LP_got:
    s_call_b64 s[62:63], LP_order
LP_n2:
    s_cmp_eq_u32 s99, 3
    s_cbranch_scc0 LP_n3
    s_call_b64 s[62:63], LP_ldlo
LP_n3:
    s_cmp_eq_u32 s36, 1
    s_mov_b32 s8, 71680
    s_cmov_b32 s8, 122880
    s_mov_b32 s9, 81920
    s_cmov_b32 s9, 133120
    s_mov_b32 s10, 92160
    s_cmov_b32 s10, 5120
    s_mov_b32 s11, 102400
    s_cmov_b32 s11, 15360
    s_mov_b32 s12, 112640
    s_cmov_b32 s12, 25600
    s_mov_b32 s13, 122880
    s_cmov_b32 s13, 71680
    s_mov_b32 s14, 133120
    s_cmov_b32 s14, 81920
    s_mov_b32 s15, 5120
    s_cmov_b32 s15, 92160
    s_mov_b32 s52, 15360
    s_cmov_b32 s52, 102400
    s_mov_b32 s53, 25600
    s_cmov_b32 s53, 112640
    s_call_b64 s[6:7], LP_pro
    s_cbranch_scc0 LP_n4
    v_swap_b32 v96, v196
    v_swap_b32 v97, v197
    v_swap_b32 v98, v198
    v_swap_b32 v99, v199
    v_swap_b32 v100, v200
    v_swap_b32 v101, v201
    v_swap_b32 v102, v202
    v_swap_b32 v103, v203
    v_swap_b32 v104, v204
    v_swap_b32 v105, v205
    v_swap_b32 v106, v206
    v_swap_b32 v107, v207
    v_swap_b32 v108, v208
    v_swap_b32 v109, v209
    v_swap_b32 v110, v210
    v_swap_b32 v111, v211
    v_swap_b32 v112, v212
    v_swap_b32 v113, v213
    v_swap_b32 v114, v214
    v_swap_b32 v115, v215
    v_swap_b32 v116, v216
    v_swap_b32 v117, v217
    v_swap_b32 v118, v218
    v_swap_b32 v119, v219
    v_swap_b32 v120, v220
    v_swap_b32 v121, v221
    v_swap_b32 v122, v222
    v_swap_b32 v123, v223
    v_swap_b32 v124, v224
    v_swap_b32 v125, v225
    v_swap_b32 v126, v226
    v_swap_b32 v127, v227
    v_swap_b32 v128, v228
    v_swap_b32 v129, v229
    v_swap_b32 v130, v230
    v_swap_b32 v131, v231
    v_swap_b32 v132, v232
    v_swap_b32 v133, v233
    v_swap_b32 v134, v234
    v_swap_b32 v135, v235
LP_n4:
    s_waitcnt vmcnt(5)
    s_cmp_eq_u32 s99, 3
    s_cbranch_scc1 LP_n5
    s_waitcnt vmcnt(0)
    v_mov_b32 v190, 0
    s_mov_b64 exec, 3
    buffer_atomic_add v190, v187, s[16:19], s39 offen sc0 sc1
    s_mov_b64 exec, -1
LP_n5:
    s_mov_b32 s60, 262144
LP_ldhi_chk:
    v_mov_b32 v188, 0
    v_mov_b32 v189, 0
    v_max3_u32 v188, v188, v136, v137
    v_max3_u32 v189, v189, v138, v139
    v_max3_u32 v188, v188, v140, v141
    v_max3_u32 v189, v189, v142, v143
    v_max3_u32 v188, v188, v144, v145
    v_max3_u32 v189, v189, v146, v147
    v_max3_u32 v188, v188, v148, v149
    v_max3_u32 v189, v189, v150, v151
    v_max3_u32 v188, v188, v152, v153
    v_max3_u32 v189, v189, v154, v155
    v_max_u32 v188, v188, v189
    v_cmp_eq_u32 vcc, -1, v188
    s_cbranch_vccz LP_ldhi_ok
    s_call_b64 s[62:63], LP_ldhi
    s_waitcnt vmcnt(0)
    s_sub_u32 s60, s60, 1
    s_cbranch_scc0 LP_ldhi_chk
LP_ldhi_ok:
    s_cmp_lg_u32 s99, 3
    s_call_b64 s[6:7], LP_hi
    s_cmp_eq_u32 s99, 3
    s_cbranch_scc1 LP_n6
    s_mov_b32 s60, 262144
    s_mov_b64 exec, 3
LF_pc10:
    v_mov_b32 v188, 0
    buffer_atomic_add v188, v187, s[16:19], s39 offen sc0 sc1
LF_pc10_w:
    s_waitcnt vmcnt(0)
    v_cmp_gt_u32 vcc, 8, v188
    s_cbranch_vccz LF_pc10_ok
    s_sleep 2
    s_sub_u32 s60, s60, 1
    s_cbranch_scc0 LF_pc10
LF_pc10_ok:
    s_mov_b64 exec, -1
    s_call_b64 s[62:63], LP_ldlo
LP_n6:
    s_mov_b32 s60, 262144
LP_ldlo_chk:
    v_mov_b32 v188, 0
    v_mov_b32 v189, 0
    s_waitcnt vmcnt(4)
    v_max3_u32 v188, v188, v156, v157
    v_max3_u32 v189, v189, v158, v159
    s_waitcnt vmcnt(3)
    v_max3_u32 v188, v188, v160, v161
    v_max3_u32 v189, v189, v162, v163
    s_waitcnt vmcnt(2)
    v_max3_u32 v188, v188, v164, v165
    v_max3_u32 v189, v189, v166, v167
    s_waitcnt vmcnt(1)
    v_max3_u32 v188, v188, v168, v169
    v_max3_u32 v189, v189, v170, v171
    s_waitcnt vmcnt(0)
    v_max3_u32 v188, v188, v172, v173
    v_max3_u32 v189, v189, v174, v175
    v_max_u32 v188, v188, v189
    v_cmp_eq_u32 vcc, -1, v188
    s_cbranch_vccz LP_ldlo_ok
    s_call_b64 s[62:63], LP_ldlo
    s_waitcnt vmcnt(0)
    s_sub_u32 s60, s60, 1
    s_cbranch_scc0 LP_ldlo_chk
LP_ldlo_ok:
    s_cmp_eq_u32 0, 1
    s_call_b64 s[6:7], LP_lo
    v_pk_add_f32 v[96:97], v[96:97], v[196:197]
    v_pk_add_f32 v[100:101], v[100:101], v[200:201]
    v_pk_add_f32 v[104:105], v[104:105], v[204:205]
    v_pk_add_f32 v[108:109], v[108:109], v[208:209]
    v_pk_add_f32 v[112:113], v[112:113], v[212:213]
    v_pk_add_f32 v[116:117], v[116:117], v[216:217]
    v_pk_add_f32 v[120:121], v[120:121], v[220:221]
    v_pk_add_f32 v[124:125], v[124:125], v[224:225]
    v_pk_add_f32 v[128:129], v[128:129], v[228:229]
    v_pk_add_f32 v[132:133], v[132:133], v[232:233]
    v_cvt_pk_bf16_f32 v16, v96, v100
    v_cvt_pk_bf16_f32 v17, v104, v108
    v_cvt_pk_bf16_f32 v18, v112, v116
    v_cvt_pk_bf16_f32 v19, v120, v124
    v_cvt_pk_bf16_f32 v20, v128, v132
    buffer_store_dwordx4 v[16:19], v4, s[20:23], s56 offen offset:0 sc1
    buffer_store_dword v20, v5, s[20:23], s56 offen offset:0 sc1
    v_cvt_pk_bf16_f32 v22, v97, v101
    v_cvt_pk_bf16_f32 v23, v105, v109
    v_cvt_pk_bf16_f32 v24, v113, v117
    v_cvt_pk_bf16_f32 v25, v121, v125
    v_cvt_pk_bf16_f32 v26, v129, v133
    buffer_store_dwordx4 v[22:25], v4, s[20:23], s56 offen offset:2560 sc1
    buffer_store_dword v26, v5, s[20:23], s56 offen offset:2560 sc1
    v_pk_add_f32 v[98:99], v[98:99], v[198:199]
    v_pk_add_f32 v[102:103], v[102:103], v[202:203]
    v_pk_add_f32 v[106:107], v[106:107], v[206:207]
    v_pk_add_f32 v[110:111], v[110:111], v[210:211]
    v_pk_add_f32 v[114:115], v[114:115], v[214:215]
    v_pk_add_f32 v[118:119], v[118:119], v[218:219]
    v_pk_add_f32 v[122:123], v[122:123], v[222:223]
    v_pk_add_f32 v[126:127], v[126:127], v[226:227]
    v_pk_add_f32 v[130:131], v[130:131], v[230:231]
    v_pk_add_f32 v[134:135], v[134:135], v[234:235]
    v_cvt_pk_bf16_f32 v28, v98, v102
    v_cvt_pk_bf16_f32 v29, v106, v110
    v_cvt_pk_bf16_f32 v30, v114, v118
    v_cvt_pk_bf16_f32 v31, v122, v126
    v_cvt_pk_bf16_f32 v32, v130, v134
    buffer_store_dwordx4 v[28:31], v4, s[20:23], s57 offen offset:0 sc1
    buffer_store_dword v32, v5, s[20:23], s57 offen offset:0 sc1
    v_cvt_pk_bf16_f32 v34, v99, v103
    v_cvt_pk_bf16_f32 v35, v107, v111
    v_cvt_pk_bf16_f32 v36, v115, v119
    v_cvt_pk_bf16_f32 v37, v123, v127
    v_cvt_pk_bf16_f32 v38, v131, v135
    buffer_store_dwordx4 v[34:37], v4, s[20:23], s57 offen offset:2560 sc1
    buffer_store_dword v38, v5, s[20:23], s57 offen offset:2560 sc1
LP_end:
LF_end:
    s_endpgm
LA_dma:
    s_add_u32 s49, s48, s43
    s_and_b32 s49, s49, 7
    s_lshl_b32 s49, s49, 1
    s_lshr_b32 s50, s41, 1
    s_add_u32 s49, s49, s50
    s_mul_i32 s49, s49, 163840
    s_lshl_b32 s51, s41, 1
    s_and_b32 s51, s51, 2
    s_lshr_b32 s51, 20480, s51
    s_mul_i32 s51, s51, s47
    s_add_u32 s49, s49, s51
    s_add_u32 s49, s49, s98
    s_add_u32 s49, s49, 2621440
    s_sub_u32 s48, s48, s47
    s_add_u32 s48, s48, 1
    s_mul_i32 s51, s48, 43
    s_lshr_b32 s51, s51, 7
    s_mul_i32 s51, s51, 3
    s_sub_u32 s48, s48, s51
    s_lshl_b32 s48, s48, 1
    s_add_u32 s48, s48, s50
    s_mul_i32 s48, s48, 11264
    s_mul_i32 s51, s47, 91136
    s_sub_u32 s48, s48, s51
    s_add_u32 s48, s48, 96256
    s_and_b32 s50, s41, 1
    s_mul_i32 s51, s50, 6144
    s_add_u32 m0, s48, s51
    s_nop 0
    buffer_load_dwordx4 v176, s[16:19], s49 offen sc1 lds
    s_add_u32 m0, m0, 1024
    s_nop 0
    buffer_load_dwordx4 v177, s[16:19], s49 offen sc1 lds
    s_add_u32 m0, m0, 1024
    s_nop 0
    buffer_load_dwordx4 v178, s[16:19], s49 offen sc1 lds
    s_add_u32 m0, m0, 1024
    s_nop 0
    buffer_load_dwordx4 v179, s[16:19], s49 offen sc1 lds
    s_add_u32 m0, m0, 1024
    s_nop 0
    buffer_load_dwordx4 v180, s[16:19], s49 offen sc1 lds
    s_add_u32 m0, m0, 1024
    s_cmp_eq_u32 s50, 1
    s_cbranch_scc1 LA_dma_ret
    buffer_load_dwordx4 v181, s[16:19], s49 offen sc1 lds
LA_dma_ret:
    s_setpc_b64 s[62:63]
LA_refill:
    s_cmp_gt_u32 s56, 5
    s_cbranch_scc1 LA_ev_b
    s_mov_b32 s47, 0
    s_add_u32 s48, s56, 2
    s_call_b64 s[62:63], LA_dma
LA_ev_b:
    s_sub_u32 s48, s56, 1
    s_cmp_lt_u32 s48, 3
    s_cbranch_scc1 LA_back
    s_mov_b32 s47, 1
    s_call_b64 s[62:63], LA_dma
    s_branch LA_back
LG_publish:
    v_cmp_lt_u32 vcc, 31, v0
    v_mov_b32 v243, s96
    v_mov_b32 v244, s97
    v_cndmask_b32 v243, v243, v244, vcc
    v_mul_u32_u24 v244, 205, v243
    v_lshrrev_b32 v244, 11, v244
    v_mul_u32_u24 v245, 10, v244
    v_sub_u32 v243, v243, v245
    v_lshlrev_b32 v243, 3, v243
    v_and_b32 v245, 31, v0
    v_lshl_add_u32 v244, v245, 2, v244
    v_lshlrev_b32 v244, 7, v244
    v_mul_u32_u24 v245, 5, v245
    v_lshrrev_b32 v245, 1, v245
    v_add_u32 v245, 2, v245
    v_sub_u32 v245, v245, v243
    v_cmp_gt_u32 vcc, 10, v245
    v_mov_b32 v241, 1
    s_lshl_b32 s48, s61, 14
    s_add_u32 s48, s48, 22609920
    s_mov_b64 exec, vcc
    buffer_atomic_add v241, v244, s[16:19], s48 offen sc1
    s_mov_b64 exec, -1
    s_setpc_b64 s[62:63]
LP_order:
    s_and_b32 s36, s99, 1
    s_xor_b32 s36, s36, 1
    s_mul_i32 s47, s36, 10240
    s_add_u32 s54, s38, s47
    s_sub_u32 s55, s38, s47
    s_add_u32 s55, s55, 10240
LP_ldhi:
    s_mov_b32 s48, s54
    buffer_load_dwordx4 v[136:139], v3, s[16:19], s48 offen offset:0 sc1
    buffer_load_dwordx4 v[140:143], v3, s[16:19], s48 offen offset:2048 sc1
    s_add_u32 s48, s48, 4096
    buffer_load_dwordx4 v[144:147], v3, s[16:19], s48 offen offset:0 sc1
    buffer_load_dwordx4 v[148:151], v3, s[16:19], s48 offen offset:2048 sc1
    s_add_u32 s48, s48, 4096
    buffer_load_dwordx4 v[152:155], v3, s[16:19], s48 offen offset:0 sc1
    s_setpc_b64 s[62:63]
LP_ldlo:
    s_mov_b32 s48, s55
    buffer_load_dwordx4 v[156:159], v3, s[16:19], s48 offen offset:0 sc1
    buffer_load_dwordx4 v[160:163], v3, s[16:19], s48 offen offset:2048 sc1
    s_add_u32 s48, s48, 4096
    buffer_load_dwordx4 v[164:167], v3, s[16:19], s48 offen offset:0 sc1
    buffer_load_dwordx4 v[168:171], v3, s[16:19], s48 offen offset:2048 sc1
    s_add_u32 s48, s48, 4096
    buffer_load_dwordx4 v[172:175], v3, s[16:19], s48 offen offset:0 sc1
    s_setpc_b64 s[62:63]
LP_pro:
    v_add_u32 v2, s8, v15
    ds_read_b128 v[16:19], v2 offset:0
    ds_read_b128 v[20:23], v2 offset:1024
    ds_read_b128 v[24:27], v2 offset:2048
    ds_read_b128 v[28:31], v2 offset:3072
    ds_read_b128 v[32:35], v2 offset:4096
    ds_read_b128 v[36:39], v2 offset:5120
    ds_read_b128 v[40:43], v2 offset:6144
    ds_read_b128 v[44:47], v2 offset:7168
    ds_read_b128 v[48:51], v2 offset:8192
    ds_read_b128 v[52:55], v2 offset:9216
    s_setpc_b64 s[6:7]
LP_hi:
    v_add_u32 v2, s9, v15
    s_waitcnt lgkmcnt(9)
    v_mfma_f32_16x16x32_bf16 v[96:99], v[136:139], v[16:19], v[96:99]
    ds_read_b128 v[56:59], v2 offset:0
    s_waitcnt lgkmcnt(9)
    v_mfma_f32_16x16x32_bf16 v[100:103], v[136:139], v[20:23], v[100:103]
    ds_read_b128 v[60:63], v2 offset:1024
    s_waitcnt lgkmcnt(9)
    v_mfma_f32_16x16x32_bf16 v[104:107], v[136:139], v[24:27], v[104:107]
    ds_read_b128 v[64:67], v2 offset:2048
    s_waitcnt lgkmcnt(9)
    v_mfma_f32_16x16x32_bf16 v[108:111], v[136:139], v[28:31], v[108:111]
    ds_read_b128 v[68:71], v2 offset:3072
    s_waitcnt lgkmcnt(9)
    v_mfma_f32_16x16x32_bf16 v[112:115], v[136:139], v[32:35], v[112:115]
    ds_read_b128 v[72:75], v2 offset:4096
    s_waitcnt lgkmcnt(9)
    v_mfma_f32_16x16x32_bf16 v[116:119], v[136:139], v[36:39], v[116:119]
    ds_read_b128 v[76:79], v2 offset:5120
    s_waitcnt lgkmcnt(9)
    v_mfma_f32_16x16x32_bf16 v[120:123], v[136:139], v[40:43], v[120:123]
    ds_read_b128 v[80:83], v2 offset:6144
    s_waitcnt lgkmcnt(9)
    v_mfma_f32_16x16x32_bf16 v[124:127], v[136:139], v[44:47], v[124:127]
    ds_read_b128 v[84:87], v2 offset:7168
    s_waitcnt lgkmcnt(9)
    v_mfma_f32_16x16x32_bf16 v[128:131], v[136:139], v[48:51], v[128:131]
    ds_read_b128 v[88:91], v2 offset:8192
    s_waitcnt lgkmcnt(9)
    v_mfma_f32_16x16x32_bf16 v[132:135], v[136:139], v[52:55], v[132:135]
    ds_read_b128 v[92:95], v2 offset:9216
    v_add_u32 v2, s10, v15
    s_waitcnt lgkmcnt(9)
    v_mfma_f32_16x16x32_bf16 v[96:99], v[140:143], v[56:59], v[96:99]
    ds_read_b128 v[16:19], v2 offset:0
    s_waitcnt lgkmcnt(9)
    v_mfma_f32_16x16x32_bf16 v[100:103], v[140:143], v[60:63], v[100:103]
    ds_read_b128 v[20:23], v2 offset:1024
    s_waitcnt lgkmcnt(9)
    v_mfma_f32_16x16x32_bf16 v[104:107], v[140:143], v[64:67], v[104:107]
    ds_read_b128 v[24:27], v2 offset:2048
    s_waitcnt lgkmcnt(9)
    v_mfma_f32_16x16x32_bf16 v[108:111], v[140:143], v[68:71], v[108:111]
    ds_read_b128 v[28:31], v2 offset:3072
    s_waitcnt lgkmcnt(9)
    v_mfma_f32_16x16x32_bf16 v[112:115], v[140:143], v[72:75], v[112:115]
    ds_read_b128 v[32:35], v2 offset:4096
    s_waitcnt lgkmcnt(9)
    v_mfma_f32_16x16x32_bf16 v[116:119], v[140:143], v[76:79], v[116:119]
    ds_read_b128 v[36:39], v2 offset:5120
    s_waitcnt lgkmcnt(9)
    v_mfma_f32_16x16x32_bf16 v[120:123], v[140:143], v[80:83], v[120:123]
    ds_read_b128 v[40:43], v2 offset:6144
    s_waitcnt lgkmcnt(9)
    v_mfma_f32_16x16x32_bf16 v[124:127], v[140:143], v[84:87], v[124:127]
    ds_read_b128 v[44:47], v2 offset:7168
    s_waitcnt lgkmcnt(9)
    v_mfma_f32_16x16x32_bf16 v[128:131], v[140:143], v[88:91], v[128:131]
    ds_read_b128 v[48:51], v2 offset:8192
    s_waitcnt lgkmcnt(9)
    v_mfma_f32_16x16x32_bf16 v[132:135], v[140:143], v[92:95], v[132:135]
    ds_read_b128 v[52:55], v2 offset:9216
    v_add_u32 v2, s11, v15
    s_waitcnt lgkmcnt(9)
    v_mfma_f32_16x16x32_bf16 v[96:99], v[144:147], v[16:19], v[96:99]
    ds_read_b128 v[56:59], v2 offset:0
    s_waitcnt lgkmcnt(9)
    v_mfma_f32_16x16x32_bf16 v[100:103], v[144:147], v[20:23], v[100:103]
    ds_read_b128 v[60:63], v2 offset:1024
    s_waitcnt lgkmcnt(9)
    v_mfma_f32_16x16x32_bf16 v[104:107], v[144:147], v[24:27], v[104:107]
    ds_read_b128 v[64:67], v2 offset:2048
    s_waitcnt lgkmcnt(9)
    v_mfma_f32_16x16x32_bf16 v[108:111], v[144:147], v[28:31], v[108:111]
    ds_read_b128 v[68:71], v2 offset:3072
    s_waitcnt lgkmcnt(9)
    v_mfma_f32_16x16x32_bf16 v[112:115], v[144:147], v[32:35], v[112:115]
    ds_read_b128 v[72:75], v2 offset:4096
    s_waitcnt lgkmcnt(9)
    v_mfma_f32_16x16x32_bf16 v[116:119], v[144:147], v[36:39], v[116:119]
    ds_read_b128 v[76:79], v2 offset:5120
    s_waitcnt lgkmcnt(9)
    v_mfma_f32_16x16x32_bf16 v[120:123], v[144:147], v[40:43], v[120:123]
    ds_read_b128 v[80:83], v2 offset:6144
    s_waitcnt lgkmcnt(9)
    v_mfma_f32_16x16x32_bf16 v[124:127], v[144:147], v[44:47], v[124:127]
    ds_read_b128 v[84:87], v2 offset:7168
    s_waitcnt lgkmcnt(9)
    v_mfma_f32_16x16x32_bf16 v[128:131], v[144:147], v[48:51], v[128:131]
    ds_read_b128 v[88:91], v2 offset:8192
    s_waitcnt lgkmcnt(9)
    v_mfma_f32_16x16x32_bf16 v[132:135], v[144:147], v[52:55], v[132:135]
    ds_read_b128 v[92:95], v2 offset:9216
    v_add_u32 v2, s12, v15
    s_waitcnt lgkmcnt(9)
    v_mfma_f32_16x16x32_bf16 v[96:99], v[148:151], v[56:59], v[96:99]
    ds_read_b128 v[16:19], v2 offset:0
    s_waitcnt lgkmcnt(9)
    v_mfma_f32_16x16x32_bf16 v[100:103], v[148:151], v[60:63], v[100:103]
    ds_read_b128 v[20:23], v2 offset:1024
    s_waitcnt lgkmcnt(9)
    v_mfma_f32_16x16x32_bf16 v[104:107], v[148:151], v[64:67], v[104:107]
    ds_read_b128 v[24:27], v2 offset:2048
    s_waitcnt lgkmcnt(9)
    v_mfma_f32_16x16x32_bf16 v[108:111], v[148:151], v[68:71], v[108:111]
    ds_read_b128 v[28:31], v2 offset:3072
    s_waitcnt lgkmcnt(9)
    v_mfma_f32_16x16x32_bf16 v[112:115], v[148:151], v[72:75], v[112:115]
    ds_read_b128 v[32:35], v2 offset:4096
    s_waitcnt lgkmcnt(9)
    v_mfma_f32_16x16x32_bf16 v[116:119], v[148:151], v[76:79], v[116:119]
    ds_read_b128 v[36:39], v2 offset:5120
    s_waitcnt lgkmcnt(9)
    v_mfma_f32_16x16x32_bf16 v[120:123], v[148:151], v[80:83], v[120:123]
    ds_read_b128 v[40:43], v2 offset:6144
    s_waitcnt lgkmcnt(9)
    v_mfma_f32_16x16x32_bf16 v[124:127], v[148:151], v[84:87], v[124:127]
    ds_read_b128 v[44:47], v2 offset:7168
    s_waitcnt lgkmcnt(9)
    v_mfma_f32_16x16x32_bf16 v[128:131], v[148:151], v[88:91], v[128:131]
    ds_read_b128 v[48:51], v2 offset:8192
    s_waitcnt lgkmcnt(9)
    v_mfma_f32_16x16x32_bf16 v[132:135], v[148:151], v[92:95], v[132:135]
    ds_read_b128 v[52:55], v2 offset:9216
    v_add_u32 v2, s13, v15
    s_waitcnt lgkmcnt(9)
    v_mfma_f32_16x16x32_bf16 v[96:99], v[152:155], v[16:19], v[96:99]
    ds_read_b128 v[56:59], v2 offset:0
    s_waitcnt lgkmcnt(9)
    v_mfma_f32_16x16x32_bf16 v[100:103], v[152:155], v[20:23], v[100:103]
    ds_read_b128 v[60:63], v2 offset:1024
    s_waitcnt lgkmcnt(9)
    v_mfma_f32_16x16x32_bf16 v[104:107], v[152:155], v[24:27], v[104:107]
    ds_read_b128 v[64:67], v2 offset:2048
    s_waitcnt lgkmcnt(9)
    v_mfma_f32_16x16x32_bf16 v[108:111], v[152:155], v[28:31], v[108:111]
    ds_read_b128 v[68:71], v2 offset:3072
    s_waitcnt lgkmcnt(9)
    v_mfma_f32_16x16x32_bf16 v[112:115], v[152:155], v[32:35], v[112:115]
    ds_read_b128 v[72:75], v2 offset:4096
    s_waitcnt lgkmcnt(9)
    v_mfma_f32_16x16x32_bf16 v[116:119], v[152:155], v[36:39], v[116:119]
    ds_read_b128 v[76:79], v2 offset:5120
    s_waitcnt lgkmcnt(9)
    v_mfma_f32_16x16x32_bf16 v[120:123], v[152:155], v[40:43], v[120:123]
    ds_read_b128 v[80:83], v2 offset:6144
    s_waitcnt lgkmcnt(9)
    v_mfma_f32_16x16x32_bf16 v[124:127], v[152:155], v[44:47], v[124:127]
    ds_read_b128 v[84:87], v2 offset:7168
    s_waitcnt lgkmcnt(9)
    v_mfma_f32_16x16x32_bf16 v[128:131], v[152:155], v[48:51], v[128:131]
    ds_read_b128 v[88:91], v2 offset:8192
    s_waitcnt lgkmcnt(9)
    v_mfma_f32_16x16x32_bf16 v[132:135], v[152:155], v[52:55], v[132:135]
    ds_read_b128 v[92:95], v2 offset:9216
    s_cbranch_scc1 LP_mid
LP_midb:
    s_setpc_b64 s[6:7]
LP_lo:
    v_add_u32 v2, s14, v15
    s_waitcnt lgkmcnt(9)
    v_mfma_f32_16x16x32_bf16 v[196:199], v[156:159], v[56:59], v[196:199]
    ds_read_b128 v[16:19], v2 offset:0
    s_cbranch_scc1 LW_0
LW_b0:
    s_waitcnt lgkmcnt(9)
    v_mfma_f32_16x16x32_bf16 v[200:203], v[156:159], v[60:63], v[200:203]
    ds_read_b128 v[20:23], v2 offset:1024
    s_waitcnt lgkmcnt(9)
    v_mfma_f32_16x16x32_bf16 v[204:207], v[156:159], v[64:67], v[204:207]
    ds_read_b128 v[24:27], v2 offset:2048
    s_waitcnt lgkmcnt(9)
    v_mfma_f32_16x16x32_bf16 v[208:211], v[156:159], v[68:71], v[208:211]
    ds_read_b128 v[28:31], v2 offset:3072
    s_waitcnt lgkmcnt(9)
    v_mfma_f32_16x16x32_bf16 v[212:215], v[156:159], v[72:75], v[212:215]
    ds_read_b128 v[32:35], v2 offset:4096
    s_waitcnt lgkmcnt(9)
    v_mfma_f32_16x16x32_bf16 v[216:219], v[156:159], v[76:79], v[216:219]
    ds_read_b128 v[36:39], v2 offset:5120
    s_cbranch_scc1 LW_1
LW_b1:
    s_waitcnt lgkmcnt(9)
    v_mfma_f32_16x16x32_bf16 v[220:223], v[156:159], v[80:83], v[220:223]
    ds_read_b128 v[40:43], v2 offset:6144
    s_waitcnt lgkmcnt(9)
    v_mfma_f32_16x16x32_bf16 v[224:227], v[156:159], v[84:87], v[224:227]
    ds_read_b128 v[44:47], v2 offset:7168
    s_waitcnt lgkmcnt(9)
    v_mfma_f32_16x16x32_bf16 v[228:231], v[156:159], v[88:91], v[228:231]
    ds_read_b128 v[48:51], v2 offset:8192
    s_waitcnt lgkmcnt(9)
    v_mfma_f32_16x16x32_bf16 v[232:235], v[156:159], v[92:95], v[232:235]
    ds_read_b128 v[52:55], v2 offset:9216
    v_add_u32 v2, s15, v15
    s_waitcnt lgkmcnt(9)
    v_mfma_f32_16x16x32_bf16 v[196:199], v[160:163], v[16:19], v[196:199]
    ds_read_b128 v[56:59], v2 offset:0
    s_cbranch_scc1 LW_2
LW_b2:
    s_waitcnt lgkmcnt(9)
    v_mfma_f32_16x16x32_bf16 v[200:203], v[160:163], v[20:23], v[200:203]
    ds_read_b128 v[60:63], v2 offset:1024
    s_waitcnt lgkmcnt(9)
    v_mfma_f32_16x16x32_bf16 v[204:207], v[160:163], v[24:27], v[204:207]
    ds_read_b128 v[64:67], v2 offset:2048
    s_waitcnt lgkmcnt(9)
    v_mfma_f32_16x16x32_bf16 v[208:211], v[160:163], v[28:31], v[208:211]
    ds_read_b128 v[68:71], v2 offset:3072
    s_waitcnt lgkmcnt(9)
    v_mfma_f32_16x16x32_bf16 v[212:215], v[160:163], v[32:35], v[212:215]
    ds_read_b128 v[72:75], v2 offset:4096
    s_waitcnt lgkmcnt(9)
    v_mfma_f32_16x16x32_bf16 v[216:219], v[160:163], v[36:39], v[216:219]
    ds_read_b128 v[76:79], v2 offset:5120
    s_cbranch_scc1 LW_3
LW_b3:
    s_waitcnt lgkmcnt(9)
    v_mfma_f32_16x16x32_bf16 v[220:223], v[160:163], v[40:43], v[220:223]
    ds_read_b128 v[80:83], v2 offset:6144
    s_waitcnt lgkmcnt(9)
    v_mfma_f32_16x16x32_bf16 v[224:227], v[160:163], v[44:47], v[224:227]
    ds_read_b128 v[84:87], v2 offset:7168
    s_waitcnt lgkmcnt(9)
    v_mfma_f32_16x16x32_bf16 v[228:231], v[160:163], v[48:51], v[228:231]
    ds_read_b128 v[88:91], v2 offset:8192
    s_waitcnt lgkmcnt(9)
    v_mfma_f32_16x16x32_bf16 v[232:235], v[160:163], v[52:55], v[232:235]
    ds_read_b128 v[92:95], v2 offset:9216
    v_add_u32 v2, s52, v15
    s_waitcnt lgkmcnt(9)
    v_mfma_f32_16x16x32_bf16 v[196:199], v[164:167], v[56:59], v[196:199]
    ds_read_b128 v[16:19], v2 offset:0
    s_cbranch_scc1 LW_4
LW_b4:
    s_waitcnt lgkmcnt(9)
    v_mfma_f32_16x16x32_bf16 v[200:203], v[164:167], v[60:63], v[200:203]
    ds_read_b128 v[20:23], v2 offset:1024
    s_waitcnt lgkmcnt(9)
    v_mfma_f32_16x16x32_bf16 v[204:207], v[164:167], v[64:67], v[204:207]
    ds_read_b128 v[24:27], v2 offset:2048
    s_waitcnt lgkmcnt(9)
    v_mfma_f32_16x16x32_bf16 v[208:211], v[164:167], v[68:71], v[208:211]
    ds_read_b128 v[28:31], v2 offset:3072
    s_waitcnt lgkmcnt(9)
    v_mfma_f32_16x16x32_bf16 v[212:215], v[164:167], v[72:75], v[212:215]
    ds_read_b128 v[32:35], v2 offset:4096
    s_waitcnt lgkmcnt(9)
    v_mfma_f32_16x16x32_bf16 v[216:219], v[164:167], v[76:79], v[216:219]
    ds_read_b128 v[36:39], v2 offset:5120
    s_cbranch_scc1 LW_5
LW_b5:
    s_waitcnt lgkmcnt(9)
    v_mfma_f32_16x16x32_bf16 v[220:223], v[164:167], v[80:83], v[220:223]
    ds_read_b128 v[40:43], v2 offset:6144
    s_waitcnt lgkmcnt(9)
    v_mfma_f32_16x16x32_bf16 v[224:227], v[164:167], v[84:87], v[224:227]
    ds_read_b128 v[44:47], v2 offset:7168
    s_waitcnt lgkmcnt(9)
    v_mfma_f32_16x16x32_bf16 v[228:231], v[164:167], v[88:91], v[228:231]
    ds_read_b128 v[48:51], v2 offset:8192
    s_waitcnt lgkmcnt(9)
    v_mfma_f32_16x16x32_bf16 v[232:235], v[164:167], v[92:95], v[232:235]
    ds_read_b128 v[52:55], v2 offset:9216
    v_add_u32 v2, s53, v15
    s_waitcnt lgkmcnt(9)
    v_mfma_f32_16x16x32_bf16 v[196:199], v[168:171], v[16:19], v[196:199]
    ds_read_b128 v[56:59], v2 offset:0
    s_cbranch_scc1 LW_6
LW_b6:
    s_waitcnt lgkmcnt(9)
    v_mfma_f32_16x16x32_bf16 v[200:203], v[168:171], v[20:23], v[200:203]
    ds_read_b128 v[60:63], v2 offset:1024
    s_waitcnt lgkmcnt(9)
    v_mfma_f32_16x16x32_bf16 v[204:207], v[168:171], v[24:27], v[204:207]
    ds_read_b128 v[64:67], v2 offset:2048
    s_waitcnt lgkmcnt(9)
    v_mfma_f32_16x16x32_bf16 v[208:211], v[168:171], v[28:31], v[208:211]
    ds_read_b128 v[68:71], v2 offset:3072
    s_waitcnt lgkmcnt(9)
    v_mfma_f32_16x16x32_bf16 v[212:215], v[168:171], v[32:35], v[212:215]
    ds_read_b128 v[72:75], v2 offset:4096
    s_waitcnt lgkmcnt(9)
    v_mfma_f32_16x16x32_bf16 v[216:219], v[168:171], v[36:39], v[216:219]
    ds_read_b128 v[76:79], v2 offset:5120
    s_cbranch_scc1 LW_7
LW_b7:
    s_waitcnt lgkmcnt(9)
    v_mfma_f32_16x16x32_bf16 v[220:223], v[168:171], v[40:43], v[220:223]
    ds_read_b128 v[80:83], v2 offset:6144
    s_waitcnt lgkmcnt(9)
    v_mfma_f32_16x16x32_bf16 v[224:227], v[168:171], v[44:47], v[224:227]
    ds_read_b128 v[84:87], v2 offset:7168
    s_waitcnt lgkmcnt(9)
    v_mfma_f32_16x16x32_bf16 v[228:231], v[168:171], v[48:51], v[228:231]
    ds_read_b128 v[88:91], v2 offset:8192
    s_waitcnt lgkmcnt(9)
    v_mfma_f32_16x16x32_bf16 v[232:235], v[168:171], v[52:55], v[232:235]
    ds_read_b128 v[92:95], v2 offset:9216
    s_waitcnt lgkmcnt(9)
    v_mfma_f32_16x16x32_bf16 v[196:199], v[172:175], v[56:59], v[196:199]
    s_cbranch_scc1 LW_8
LW_b8:
    s_waitcnt lgkmcnt(8)
    v_mfma_f32_16x16x32_bf16 v[200:203], v[172:175], v[60:63], v[200:203]
    s_waitcnt lgkmcnt(7)
    v_mfma_f32_16x16x32_bf16 v[204:207], v[172:175], v[64:67], v[204:207]
    s_waitcnt lgkmcnt(6)
    v_mfma_f32_16x16x32_bf16 v[208:211], v[172:175], v[68:71], v[208:211]
    s_waitcnt lgkmcnt(5)
    v_mfma_f32_16x16x32_bf16 v[212:215], v[172:175], v[72:75], v[212:215]
    s_waitcnt lgkmcnt(4)
    v_mfma_f32_16x16x32_bf16 v[216:219], v[172:175], v[76:79], v[216:219]
    s_waitcnt lgkmcnt(3)
    v_mfma_f32_16x16x32_bf16 v[220:223], v[172:175], v[80:83], v[220:223]
    s_waitcnt lgkmcnt(2)
    v_mfma_f32_16x16x32_bf16 v[224:227], v[172:175], v[84:87], v[224:227]
    s_waitcnt lgkmcnt(1)
    v_mfma_f32_16x16x32_bf16 v[228:231], v[172:175], v[88:91], v[228:231]
    s_waitcnt lgkmcnt(0)
    v_mfma_f32_16x16x32_bf16 v[232:235], v[172:175], v[92:95], v[232:235]
    s_setpc_b64 s[6:7]
LW_0:
    s_mul_i32 s48, s41, 15360
    s_add_u32 s49, s47, s48
    s_add_u32 m0, s48, 81920
    s_cmp_eq_u32 0, 0
    buffer_load_dwordx4 v15, s[16:19], s49 offen offset:0 sc1 lds
    buffer_load_dwordx4 v15, s[16:19], s49 offen offset:1024 sc1 lds
    buffer_load_dwordx4 v15, s[16:19], s49 offen offset:2048 sc1 lds
    s_branch LW_b0
LW_1:
    s_add_u32 m0, m0, 3072
    s_add_u32 s49, s49, 3072
    s_cmp_eq_u32 0, 0
    buffer_load_dwordx4 v15, s[16:19], s49 offen offset:0 sc1 lds
    buffer_load_dwordx4 v15, s[16:19], s49 offen offset:1024 sc1 lds
    buffer_load_dwordx4 v15, s[16:19], s49 offen offset:2048 sc1 lds
    s_branch LW_b1
LW_2:
    s_add_u32 m0, m0, 3072
    s_add_u32 s49, s49, 3072
    s_cmp_eq_u32 0, 0
    buffer_load_dwordx4 v15, s[16:19], s49 offen offset:0 sc1 lds
    buffer_load_dwordx4 v15, s[16:19], s49 offen offset:1024 sc1 lds
    buffer_load_dwordx4 v15, s[16:19], s49 offen offset:2048 sc1 lds
    s_branch LW_b2
LW_3:
    s_add_u32 m0, m0, 3072
    s_add_u32 s49, s49, 3072
    s_cmp_eq_u32 0, 0
    buffer_load_dwordx4 v15, s[16:19], s49 offen offset:0 sc1 lds
    buffer_load_dwordx4 v15, s[16:19], s49 offen offset:1024 sc1 lds
    buffer_load_dwordx4 v15, s[16:19], s49 offen offset:2048 sc1 lds
    s_branch LW_b3
LW_4:
    s_add_u32 m0, m0, 3072
    s_add_u32 s49, s49, 3072
    s_cmp_eq_u32 0, 0
    buffer_load_dwordx4 v15, s[16:19], s49 offen offset:0 sc1 lds
    buffer_load_dwordx4 v15, s[16:19], s49 offen offset:1024 sc1 lds
    buffer_load_dwordx4 v15, s[16:19], s49 offen offset:2048 sc1 lds
    s_branch LW_b4
LW_5:
    s_lshl_b32 s48, s41, 13
    s_add_u32 s49, s47, s48
    s_add_u32 s49, s49, 61440
    s_add_u32 m0, s48, 5120
    s_cmp_eq_u32 0, 0
    buffer_load_dwordx4 v15, s[16:19], s49 offen offset:0 sc1 lds
    buffer_load_dwordx4 v15, s[16:19], s49 offen offset:1024 sc1 lds
    s_branch LW_b5
LW_6:
    s_add_u32 m0, m0, 2048
    s_add_u32 s49, s49, 2048
    s_cmp_eq_u32 0, 0
    buffer_load_dwordx4 v15, s[16:19], s49 offen offset:0 sc1 lds
    buffer_load_dwordx4 v15, s[16:19], s49 offen offset:1024 sc1 lds
    s_branch LW_b6
LW_7:
    s_add_u32 m0, m0, 2048
    s_add_u32 s49, s49, 2048
    s_cmp_eq_u32 0, 0
    v_mov_b32 v190, 0
    s_mov_b64 exec, 3
    buffer_atomic_add v190, v187, s[16:19], s39 offen sc0 sc1
    s_mov_b64 exec, -1
    buffer_load_dwordx4 v15, s[16:19], s49 offen offset:0 sc1 lds
    buffer_load_dwordx4 v15, s[16:19], s49 offen offset:1024 sc1 lds
    s_branch LW_b7
LW_8:
    s_add_u32 m0, m0, 2048
    s_add_u32 s49, s49, 2048
    s_cmp_eq_u32 0, 0
    buffer_load_dwordx4 v15, s[16:19], s49 offen offset:0 sc1 lds
    buffer_load_dwordx4 v15, s[16:19], s49 offen offset:1024 sc1 lds
    s_branch LW_b8
LP_mid:
    s_waitcnt vmcnt(0)
    v_cmp_le_u32 vcc, 8, v190
    s_and_b32 s99, vcc_lo, 3
    s_cmp_eq_u32 s99, 3
    s_cbranch_scc0 LP_midb
    s_call_b64 s[62:63], LP_ldlo
    s_branch LP_midb
LR_step:
    s_add_u32 s96, s96, 1
    s_and_b32 s50, s38, 3
    s_lshl_b32 s51, s61, 2
    s_add_u32 s51, s51, s50
    s_cmp_eq_u32 s39, 0
    s_cbranch_scc1 LR_load
    s_cmp_eq_u32 s39, 1
    s_cbranch_scc0 LR_s2
    s_lshr_b32 s49, s38, 2
    s_mul_i32 s47, s51, 204800
    s_mul_i32 s49, s49, 10240
    s_add_u32 s47, s47, s49
    s_add_u32 s47, s47, 20971520
    ds_read_b64_tr_b16 v[208:209], v199 offset:0
    ds_read_b64_tr_b16 v[210:211], v199 offset:1280
    ds_read_b64_tr_b16 v[212:213], v199 offset:32
    ds_read_b64_tr_b16 v[214:215], v199 offset:1312
    ds_read_b64_tr_b16 v[216:217], v199 offset:64
    ds_read_b64_tr_b16 v[218:219], v199 offset:1344
    ds_read_b64_tr_b16 v[220:221], v199 offset:96
    ds_read_b64_tr_b16 v[222:223], v199 offset:1376
    ds_read_b64_tr_b16 v[224:225], v199 offset:128
    ds_read_b64_tr_b16 v[226:227], v199 offset:1408
    s_waitcnt lgkmcnt(0)
    ds_read_b64_tr_b16 v[228:229], v199 offset:160
    ds_read_b64_tr_b16 v[230:231], v199 offset:1440
    ds_read_b64_tr_b16 v[232:233], v199 offset:192
    ds_read_b64_tr_b16 v[234:235], v199 offset:1472
    ds_read_b64_tr_b16 v[236:237], v199 offset:224
    ds_read_b64_tr_b16 v[238:239], v199 offset:1504
    ds_read_b64_tr_b16 v[240:241], v200 offset:0
    ds_read_b64_tr_b16 v[242:243], v200 offset:1280
    ds_read_b64_tr_b16 v[244:245], v200 offset:32
    ds_read_b64_tr_b16 v[246:247], v200 offset:1312
    s_waitcnt lgkmcnt(0)
    ds_write_b128 v201, v[208:211] offset:0
    ds_write_b128 v201, v[212:215] offset:32
    ds_write_b128 v201, v[216:219] offset:64
    ds_write_b128 v201, v[220:223] offset:96
    ds_write_b128 v201, v[224:227] offset:128
    ds_write_b128 v201, v[228:231] offset:160
    ds_write_b128 v201, v[232:235] offset:192
    ds_write_b128 v201, v[236:239] offset:224
    ds_write_b128 v202, v[240:243] offset:8320
    ds_write_b128 v202, v[244:247] offset:8448
    s_waitcnt lgkmcnt(0)
    ds_read_b128 v[208:211], v205 offset:0
    ds_read_b128 v[212:215], v205 offset:1040
    ds_read_b128 v[216:219], v205 offset:2080
    ds_read_b128 v[220:223], v205 offset:3120
    ds_read_b128 v[224:227], v205 offset:4160
    ds_read_b128 v[228:231], v205 offset:5200
    ds_read_b128 v[232:235], v205 offset:6240
    ds_read_b128 v[236:239], v205 offset:7280
    ds_read_b128 v[240:243], v205 offset:8320
    ds_read_b128 v[244:247], v205 offset:9360
    s_waitcnt lgkmcnt(9)
    buffer_store_dwordx4 v[208:211], v15, s[16:19], s47 offen offset:0 sc1
    s_waitcnt lgkmcnt(8)
    buffer_store_dwordx4 v[212:215], v15, s[16:19], s47 offen offset:1024 sc1
    s_waitcnt lgkmcnt(7)
    buffer_store_dwordx4 v[216:219], v15, s[16:19], s47 offen offset:2048 sc1
    s_waitcnt lgkmcnt(6)
    buffer_store_dwordx4 v[220:223], v15, s[16:19], s47 offen offset:3072 sc1
    s_add_u32 s47, s47, 4096
    s_waitcnt lgkmcnt(5)
    buffer_store_dwordx4 v[224:227], v15, s[16:19], s47 offen offset:0 sc1
    s_waitcnt lgkmcnt(4)
    buffer_store_dwordx4 v[228:231], v15, s[16:19], s47 offen offset:1024 sc1
    s_waitcnt lgkmcnt(3)
    buffer_store_dwordx4 v[232:235], v15, s[16:19], s47 offen offset:2048 sc1
    s_waitcnt lgkmcnt(2)
    buffer_store_dwordx4 v[236:239], v15, s[16:19], s47 offen offset:3072 sc1
    s_add_u32 s47, s47, 4096
    s_waitcnt lgkmcnt(1)
    buffer_store_dwordx4 v[240:243], v15, s[16:19], s47 offen offset:0 sc1
    s_waitcnt lgkmcnt(0)
    buffer_store_dwordx4 v[244:247], v15, s[16:19], s47 offen offset:1024 sc1
    s_mov_b32 s39, 2
    s_cmp_lt_u32 s38, 16
    s_cbranch_scc0 LA_bar
    s_add_u32 s38, s38, 64
LR_load:
    s_mov_b32 s39, 1
    s_mov_b32 s12, s30
    s_and_b32 s13, s31, 0xffff
    s_mov_b32 s14, 819200
    s_mov_b32 s15, 0x00020000
    s_lshr_b32 s49, s38, 2
    s_mul_i32 s47, s49, 40960
    s_mul_i32 s48, s50, 320
    s_add_u32 s47, s47, s48
    s_mov_b32 m0, 72704
    s_add_u32 s48, s47, 20480
    buffer_load_dwordx4 v194, s[12:15], s47 offen lds
    s_add_u32 m0, m0, 1024
    s_nop 0
    buffer_load_dwordx4 v195, s[12:15], s47 offen lds
    s_add_u32 m0, m0, 1024
    s_nop 0
    buffer_load_dwordx4 v196, s[12:15], s47 offen lds
    s_add_u32 m0, m0, 1024
    s_nop 0
    buffer_load_dwordx4 v197, s[12:15], s47 offen lds
    s_add_u32 m0, m0, 1024
    s_nop 0
    buffer_load_dwordx4 v198, s[12:15], s47 offen lds
    s_add_u32 m0, m0, 1024
    s_nop 0
    buffer_load_dwordx4 v194, s[12:15], s48 offen lds
    s_add_u32 m0, m0, 1024
    s_nop 0
    buffer_load_dwordx4 v195, s[12:15], s48 offen lds
    s_add_u32 m0, m0, 1024
    s_nop 0
    buffer_load_dwordx4 v196, s[12:15], s48 offen lds
    s_add_u32 m0, m0, 1024
    s_nop 0
    buffer_load_dwordx4 v197, s[12:15], s48 offen lds
    s_add_u32 m0, m0, 1024
    s_nop 0
    buffer_load_dwordx4 v198, s[12:15], s48 offen lds
    s_add_u32 m0, m0, 1024
    s_nop 0
    s_branch LA_bar
LR_s2:
    s_mov_b32 s96, -1
    s_lshl_b32 s47, s51, 7
    s_add_u32 s47, s47, 22667264
    v_mov_b32 v182, 0
    v_mov_b32 v183, 1
    s_mov_b64 exec, 1
    buffer_atomic_add v183, v182, s[16:19], s47 offen sc1
    s_mov_b64 exec, -1
    s_branch LA_bar
LA_slow:
    v_mov_b32 v112, 0xff800000
    v_mov_b32 v113, 0xff800000
    s_add_u32 s47, s98, 2621440
    s_add_u32 s48, s47, s58
    s_add_u32 s49, s47, s59
    s_mov_b32 s55, 0
LA_slow_max:
    buffer_load_dwordx4 v[16:19], v15, s[16:19], s48 offen sc1
    buffer_load_dwordx2 v[24:25], v46, s[16:19], s49 offen sc1
    s_add_u32 s49, s49, 81920
    s_add_u32 s48, s48, 40960
    s_waitcnt vmcnt(0)
    v_mfma_f32_32x32x16_bf16 v[80:95], v[16:19], v[4:7], 0
    v_mfma_f32_32x32x16_bf16 v[96:111], v[16:19], v[8:11], 0
    s_nop 9
    v_mfma_f32_32x32x4_2b_bf16 v[80:111], v[24:25], v[12:13], v[80:111] cbsz:1 abid:0
    s_nop 15
    s_nop 3
    v_max3_f32 v114, v80, v81, v82
    v_max3_f32 v114, v114, v83, v84
    v_max3_f32 v114, v114, v85, v86
    v_max3_f32 v114, v114, v87, v88
    v_max3_f32 v114, v114, v89, v90
    v_max3_f32 v114, v114, v91, v92
    v_max3_f32 v114, v114, v93, v94
    v_max_f32 v114, v114, v95
    v_max3_f32 v115, v96, v97, v98
    v_max3_f32 v115, v115, v99, v100
    v_max3_f32 v115, v115, v101, v102
    v_max3_f32 v115, v115, v103, v104
    v_max3_f32 v115, v115, v105, v106
    v_max3_f32 v115, v115, v107, v108
    v_max3_f32 v115, v115, v109, v110
    v_max_f32 v115, v115, v111
    v_max_f32 v112, v112, v114
    v_max_f32 v113, v113, v115
    buffer_load_dwordx4 v[16:19], v15, s[16:19], s48 offen sc1
    s_add_u32 s48, s48, 40960
    s_waitcnt vmcnt(0)
    v_mfma_f32_32x32x16_bf16 v[80:95], v[16:19], v[4:7], 0
    v_mfma_f32_32x32x16_bf16 v[96:111], v[16:19], v[8:11], 0
    s_nop 9
    v_mfma_f32_32x32x4_2b_bf16 v[80:111], v[24:25], v[12:13], v[80:111] cbsz:1 abid:1
    s_nop 15
    s_nop 3
    v_max3_f32 v114, v80, v81, v82
    v_max3_f32 v114, v114, v83, v84
    v_max3_f32 v114, v114, v85, v86
    v_max3_f32 v114, v114, v87, v88
    v_max3_f32 v114, v114, v89, v90
    v_max3_f32 v114, v114, v91, v92
    v_max3_f32 v114, v114, v93, v94
    v_max_f32 v114, v114, v95
    v_max3_f32 v115, v96, v97, v98
    v_max3_f32 v115, v115, v99, v100
    v_max3_f32 v115, v115, v101, v102
    v_max3_f32 v115, v115, v103, v104
    v_max3_f32 v115, v115, v105, v106
    v_max3_f32 v115, v115, v107, v108
    v_max3_f32 v115, v115, v109, v110
    v_max_f32 v115, v115, v111
    v_max_f32 v112, v112, v114
    v_max_f32 v113, v113, v115
    s_add_u32 s55, s55, 1
    s_cmp_lt_u32 s55, 32
    s_cbranch_scc1 LA_slow_max
    v_mov_b32 v114, v112
    s_nop 1
    v_permlane32_swap_b32 v114, v112
    s_nop 1
    v_max_f32 v112, v112, v114
    v_mov_b32 v114, v113
    s_nop 1
    v_permlane32_swap_b32 v114, v113
    s_nop 1
    v_max_f32 v113, v113, v114
    v_sub_f32 v48, 0, v112
    v_sub_f32 v49, 0, v112
    v_sub_f32 v50, 0, v112
    v_sub_f32 v51, 0, v112
    v_sub_f32 v52, 0, v112
    v_sub_f32 v53, 0, v112
    v_sub_f32 v54, 0, v112
    v_sub_f32 v55, 0, v112
    v_sub_f32 v56, 0, v112
    v_sub_f32 v57, 0, v112
    v_sub_f32 v58, 0, v112
    v_sub_f32 v59, 0, v112
    v_sub_f32 v60, 0, v112
    v_sub_f32 v61, 0, v112
    v_sub_f32 v62, 0, v112
    v_sub_f32 v63, 0, v112
    v_sub_f32 v64, 0, v113
    v_sub_f32 v65, 0, v113
    v_sub_f32 v66, 0, v113
    v_sub_f32 v67, 0, v113
    v_sub_f32 v68, 0, v113
    v_sub_f32 v69, 0, v113
    v_sub_f32 v70, 0, v113
    v_sub_f32 v71, 0, v113
    v_sub_f32 v72, 0, v113
    v_sub_f32 v73, 0, v113
    v_sub_f32 v74, 0, v113
    v_sub_f32 v75, 0, v113
    v_sub_f32 v76, 0, v113
    v_sub_f32 v77, 0, v113
    v_sub_f32 v78, 0, v113
    v_sub_f32 v79, 0, v113
    v_mov_b32 v144, 0
    v_mov_b32 v145, 0
    v_mov_b32 v146, 0
    v_mov_b32 v147, 0
    v_mov_b32 v148, 0
    v_mov_b32 v149, 0
    v_mov_b32 v150, 0
    v_mov_b32 v151, 0
    v_mov_b32 v152, 0
    v_mov_b32 v153, 0
    v_mov_b32 v154, 0
    v_mov_b32 v155, 0
    v_mov_b32 v156, 0
    v_mov_b32 v157, 0
    v_mov_b32 v158, 0
    v_mov_b32 v159, 0
    v_mov_b32 v160, 0
    v_mov_b32 v161, 0
    v_mov_b32 v162, 0
    v_mov_b32 v163, 0
    v_mov_b32 v164, 0
    v_mov_b32 v165, 0
    v_mov_b32 v166, 0
    v_mov_b32 v167, 0
    v_mov_b32 v168, 0
    v_mov_b32 v169, 0
    v_mov_b32 v170, 0
    v_mov_b32 v171, 0
    v_mov_b32 v172, 0
    v_mov_b32 v173, 0
    v_mov_b32 v174, 0
    v_mov_b32 v175, 0
    v_mov_b32 v28, 0x3f803f80
    v_mov_b32 v29, 0x3f803f80
    v_mov_b32 v30, 0x3f803f80
    v_mov_b32 v31, 0x3f803f80
    v_mov_b32 v32, 0x3f803f80
    v_mov_b32 v33, 0x3f803f80
    v_mov_b32 v34, 0x3f803f80
    v_mov_b32 v35, 0x3f803f80
    s_add_u32 s47, s98, 2621440
    s_add_u32 s48, s47, s58
    s_add_u32 s49, s47, s59
    s_mov_b32 s55, 0
    s_mul_i32 s50, s43, 320
    s_add_u32 s50, s50, s47
    s_add_u32 s50, s50, 2621440
LA_slow_pv:
    buffer_load_dwordx4 v[16:19], v15, s[16:19], s48 offen sc1
    buffer_load_dwordx2 v[24:25], v46, s[16:19], s49 offen sc1
    s_add_u32 s49, s49, 81920
    s_add_u32 s48, s48, 40960
    s_add_u32 s51, s50, 20480
    s_mov_b32 exec_lo, 0xfffff
    s_mov_b32 exec_hi, 0xfffff
    buffer_load_dwordx4 v[28:31], v47, s[16:19], s50 offen sc1
    buffer_load_dwordx4 v[32:35], v47, s[16:19], s51 offen sc1
    s_mov_b64 exec, -1
    s_add_u32 s50, s50, 40960
    s_waitcnt vmcnt(2)
    v_mfma_f32_32x32x16_bf16 v[80:95], v[16:19], v[4:7], v[48:63]
    v_mfma_f32_32x32x16_bf16 v[96:111], v[16:19], v[8:11], v[64:79]
    s_nop 9
    v_mfma_f32_32x32x4_2b_bf16 v[80:111], v[24:25], v[12:13], v[80:111] cbsz:1 abid:0
    s_nop 15
    s_nop 3
    v_exp_f32 v80, v80
    v_exp_f32 v81, v81
    v_exp_f32 v82, v82
    v_exp_f32 v83, v83
    v_exp_f32 v84, v84
    v_exp_f32 v85, v85
    v_exp_f32 v86, v86
    v_exp_f32 v87, v87
    v_exp_f32 v88, v88
    v_exp_f32 v89, v89
    v_exp_f32 v90, v90
    v_exp_f32 v91, v91
    v_exp_f32 v92, v92
    v_exp_f32 v93, v93
    v_exp_f32 v94, v94
    v_exp_f32 v95, v95
    v_exp_f32 v96, v96
    v_exp_f32 v97, v97
    v_exp_f32 v98, v98
    v_exp_f32 v99, v99
    v_exp_f32 v100, v100
    v_exp_f32 v101, v101
    v_exp_f32 v102, v102
    v_exp_f32 v103, v103
    v_exp_f32 v104, v104
    v_exp_f32 v105, v105
    v_exp_f32 v106, v106
    v_exp_f32 v107, v107
    v_exp_f32 v108, v108
    v_exp_f32 v109, v109
    v_exp_f32 v110, v110
    v_exp_f32 v111, v111
    s_nop 0
    v_cvt_pk_bf16_f32 v80, v80, v81
    v_cvt_pk_bf16_f32 v81, v82, v83
    v_cvt_pk_bf16_f32 v82, v84, v85
    v_cvt_pk_bf16_f32 v83, v86, v87
    v_cvt_pk_bf16_f32 v88, v88, v89
    v_cvt_pk_bf16_f32 v89, v90, v91
    v_cvt_pk_bf16_f32 v90, v92, v93
    v_cvt_pk_bf16_f32 v91, v94, v95
    v_cvt_pk_bf16_f32 v96, v96, v97
    v_cvt_pk_bf16_f32 v97, v98, v99
    v_cvt_pk_bf16_f32 v98, v100, v101
    v_cvt_pk_bf16_f32 v99, v102, v103
    v_cvt_pk_bf16_f32 v104, v104, v105
    v_cvt_pk_bf16_f32 v105, v106, v107
    v_cvt_pk_bf16_f32 v106, v108, v109
    v_cvt_pk_bf16_f32 v107, v110, v111
    s_waitcnt vmcnt(0)
    s_nop 1
    v_mfma_f32_32x32x16_bf16 v[144:159], v[28:31], v[80:83], v[144:159]
    v_mfma_f32_32x32x16_bf16 v[144:159], v[32:35], v[88:91], v[144:159]
    v_mfma_f32_32x32x16_bf16 v[160:175], v[28:31], v[96:99], v[160:175]
    v_mfma_f32_32x32x16_bf16 v[160:175], v[32:35], v[104:107], v[160:175]
    buffer_load_dwordx4 v[16:19], v15, s[16:19], s48 offen sc1
    s_add_u32 s48, s48, 40960
    s_add_u32 s51, s50, 20480
    s_mov_b32 exec_lo, 0xfffff
    s_mov_b32 exec_hi, 0xfffff
    buffer_load_dwordx4 v[28:31], v47, s[16:19], s50 offen sc1
    buffer_load_dwordx4 v[32:35], v47, s[16:19], s51 offen sc1
    s_mov_b64 exec, -1
    s_add_u32 s50, s50, 40960
    s_waitcnt vmcnt(2)
    v_mfma_f32_32x32x16_bf16 v[80:95], v[16:19], v[4:7], v[48:63]
    v_mfma_f32_32x32x16_bf16 v[96:111], v[16:19], v[8:11], v[64:79]
    s_nop 9
    v_mfma_f32_32x32x4_2b_bf16 v[80:111], v[24:25], v[12:13], v[80:111] cbsz:1 abid:1
    s_nop 15
    s_nop 3
    v_exp_f32 v80, v80
    v_exp_f32 v81, v81
    v_exp_f32 v82, v82
    v_exp_f32 v83, v83
    v_exp_f32 v84, v84
    v_exp_f32 v85, v85
    v_exp_f32 v86, v86
    v_exp_f32 v87, v87
    v_exp_f32 v88, v88
    v_exp_f32 v89, v89
    v_exp_f32 v90, v90
    v_exp_f32 v91, v91
    v_exp_f32 v92, v92
    v_exp_f32 v93, v93
    v_exp_f32 v94, v94
    v_exp_f32 v95, v95
    v_exp_f32 v96, v96
    v_exp_f32 v97, v97
    v_exp_f32 v98, v98
    v_exp_f32 v99, v99
    v_exp_f32 v100, v100
    v_exp_f32 v101, v101
    v_exp_f32 v102, v102
    v_exp_f32 v103, v103
    v_exp_f32 v104, v104
    v_exp_f32 v105, v105
    v_exp_f32 v106, v106
    v_exp_f32 v107, v107
    v_exp_f32 v108, v108
    v_exp_f32 v109, v109
    v_exp_f32 v110, v110
    v_exp_f32 v111, v111
    s_nop 0
    v_cvt_pk_bf16_f32 v80, v80, v81
    v_cvt_pk_bf16_f32 v81, v82, v83
    v_cvt_pk_bf16_f32 v82, v84, v85
    v_cvt_pk_bf16_f32 v83, v86, v87
    v_cvt_pk_bf16_f32 v88, v88, v89
    v_cvt_pk_bf16_f32 v89, v90, v91
    v_cvt_pk_bf16_f32 v90, v92, v93
    v_cvt_pk_bf16_f32 v91, v94, v95
    v_cvt_pk_bf16_f32 v96, v96, v97
    v_cvt_pk_bf16_f32 v97, v98, v99
    v_cvt_pk_bf16_f32 v98, v100, v101
    v_cvt_pk_bf16_f32 v99, v102, v103
    v_cvt_pk_bf16_f32 v104, v104, v105
    v_cvt_pk_bf16_f32 v105, v106, v107
    v_cvt_pk_bf16_f32 v106, v108, v109
    v_cvt_pk_bf16_f32 v107, v110, v111
    s_waitcnt vmcnt(0)
    s_nop 1
    v_mfma_f32_32x32x16_bf16 v[144:159], v[28:31], v[80:83], v[144:159]
    v_mfma_f32_32x32x16_bf16 v[144:159], v[32:35], v[88:91], v[144:159]
    v_mfma_f32_32x32x16_bf16 v[160:175], v[28:31], v[96:99], v[160:175]
    v_mfma_f32_32x32x16_bf16 v[160:175], v[32:35], v[104:107], v[160:175]
    s_add_u32 s55, s55, 1
    s_cmp_lt_u32 s55, 32
    s_cbranch_scc1 LA_slow_pv
    s_nop 15
    s_mov_b32 s55, 1
    s_branch LA_epi
LF_codeend:
.section .rodata,"a"
.p2align 6
.amdhsa_kernel concat_heads__softmax_full_mha__mha_block__prompt_kernel
  .amdhsa_next_free_vgpr 256
  .amdhsa_next_free_sgpr 100
  .amdhsa_accum_offset 256
  .amdhsa_group_segment_fixed_size 0
  .amdhsa_kernarg_size 72
  .amdhsa_user_sgpr_count 2
  .amdhsa_user_sgpr_kernarg_segment_ptr 1
  .amdhsa_system_sgpr_workgroup_id_x 1
.end_amdhsa_kernel
```
